```python
import torch

def _softmax(x, axis=-1):
    return torch.softmax(x, dim=axis)
def _gelu(x):
    return torch.nn.functional.gelu(x, approximate="tanh")
def _silu(x):
    return torch.nn.functional.silu(x)
def _sigmoid(x):
    return torch.sigmoid(x)
def _layernorm(x, axis=-1, eps=1e-5):
    m = x.mean(dim=axis, keepdim=True)
    v = x.var(dim=axis, keepdim=True, unbiased=False)
    return (x - m) / torch.sqrt(v + eps)
def _scatter_add(tgt, idx, src, axis=0):
    return tgt.clone().index_add_(axis, idx, src)
def _segment_sum(src, seg, n):
    out = torch.zeros((n,) + src.shape[1:], dtype=src.dtype)
    return out.index_add_(0, seg, src)
def _pad(x, pw):
    flat = tuple(v for pair in reversed(pw) for v in pair)
    return torch.nn.functional.pad(x, flat)

kernel_name = 'concat_heads__ssm_conv_s4d__ssm_conv_h3__prompt'

def setup_inputs():

    _w = (lambda a: (lambda t: t.to(torch.bfloat16) if t.is_floating_point() else t)(torch.as_tensor(a)))
    def _A_setup():
        Bsz, L, D, N = 1, 2048, 512, 128
        return {
            "u": _w((lambda *s: torch.randn(*s, dtype=torch.bfloat16) * 0.05)(Bsz, L, D)),
            "log_A_real": _w((lambda *s: torch.randn(*s, dtype=torch.bfloat16) * 3.2)(D, N) * 0.5),
            "A_imag": _w((lambda *s: torch.randn(*s, dtype=torch.bfloat16) * 0.1)(D, N) * 3.14),
            "C_real": _w((lambda *s: torch.randn(*s, dtype=torch.bfloat16) * 0.1)(D, N) / N ** 0.5),
            "C_imag": _w((lambda *s: torch.randn(*s, dtype=torch.bfloat16) * 0.1)(D, N) / N ** 0.5),
            "log_dt": _w((lambda *s: torch.randn(*s, dtype=torch.bfloat16) * 0.05)(D) * 0.5 - 4.0),
            "D_skip": _w((lambda *s: torch.randn(*s, dtype=torch.bfloat16) * 0.05)(D)),
        }
    _A_in = _A_setup()

    def _B_setup():
        B, S, D = 1, 2048, 512
        ks = 4
        return {
            "q": _w((lambda *s: torch.randn(*s, dtype=torch.bfloat16) * 0.05)(B, S, D)),
            "k": _w((lambda *s: torch.randn(*s, dtype=torch.bfloat16) * 0.4)(B, S, D)),
            "v": _w((lambda *s: torch.randn(*s, dtype=torch.bfloat16) * 0.2)(B, S, D)),
            "shift_k": _w((lambda *s: torch.randn(*s, dtype=torch.bfloat16) * 0.4)(D, ks) * 0.5),
            "ssm_k": _w((lambda *s: torch.randn(*s, dtype=torch.bfloat16) * 0.4)(D, S) * (1.0 / S ** 0.5)),
            "ssm_D": _w((lambda *s: torch.randn(*s, dtype=torch.bfloat16) * 0.2)(D)),
        }
    _B_in = _B_setup()

    return {
        "A_u": _A_in["u"],
        "A_log_A_real": _A_in["log_A_real"],
        "A_A_imag": _A_in["A_imag"],
        "A_C_real": _A_in["C_real"],
        "A_C_imag": _A_in["C_imag"],
        "A_log_dt": _A_in["log_dt"],
        "A_D_skip": _A_in["D_skip"],
        "B_q": _B_in["q"],
        "B_k": _B_in["k"],
        "B_v": _B_in["v"],
        "B_shift_k": _B_in["shift_k"],
        "B_ssm_k": _B_in["ssm_k"],
        "B_ssm_D": _B_in["ssm_D"],
    }

def reference(A_u, A_log_A_real, A_A_imag, A_C_real, A_C_imag, A_log_dt, A_D_skip, B_q, B_k, B_v, B_shift_k, B_ssm_k, B_ssm_D):
    def _A_ref(u, log_A_real, A_imag, C_real, C_imag, log_dt, D_skip):
        L = u.shape[1]
        dt = torch.exp(log_dt)
        A = -torch.exp(log_A_real) + 1j * A_imag
        C = (C_real + 1j * C_imag) * dt[:, None]
        pos = (lambda x, dt: x.to(dt))(torch.arange(L), log_dt.dtype)
        P = torch.exp((A * dt[:, None])[:, :, None] * pos[None, None, :])
        K = 2.0 * torch.einsum("dn,dnl->dl", C, P).real
        L2 = 2 * L
        u_t = (lambda x, *d: x.permute(*d))(u, 0, 2, 1)
        Kf = (lambda x, *a, **k: torch.fft.rfft(x.float(), *a, **k))(K, L2)
        Uf = (lambda x, *a, **k: torch.fft.rfft(x.float(), *a, **k))(u_t, L2)
        y = (lambda x, *a, **k: torch.fft.irfft(x, *a, **k).to(torch.bfloat16))(Uf * Kf[None, :, :], L2)[:, :, :L]
        y = (lambda x, *d: x.permute(*d))(y, 0, 2, 1)
        return y + u * D_skip[None, None, :]

    def _B_ref(q, k, v, shift_k, ssm_k, ssm_D):
        B, S, D = q.shape
        ks = shift_k.shape[-1]
        k_pad = _pad(k, ((0, 0), (ks - 1, 0), (0, 0)))
        k_shift = torch.zeros_like(k)
        for t in range(ks):
            k_shift = k_shift + k_pad[:, t:t + S, :] * shift_k[:, ks - 1 - t][None, None, :]
        kv = k_shift * v
        L = 2 * S
        kv_pad = _pad(kv, ((0, 0), (0, S), (0, 0)))
        kf_pad = _pad(ssm_k, ((0, 0), (0, S)))
        kv_f = (lambda x, axes=(-2,-1): torch.fft.rfft2(x.float(), dim=axes))(kv_pad[:, None, :, :], axes=(1, 2))
        kf_f = (lambda x, axes=(-2,-1): torch.fft.rfft2(x.float(), dim=axes))(kf_pad[:, None, :], axes=(1, 2))
        kf_f = (lambda x, *d: x.permute(*d))(kf_f, 1, 2, 0)
        y_f = kv_f * kf_f[None, :, :, :]
        y = (lambda x, s, axes=(-2,-1): torch.fft.irfft2(x, s=s, dim=axes).to(torch.bfloat16))(y_f, (1, L), axes=(1, 2))[:, 0, :S, :]
        y = y + kv * ssm_D[None, None, :]
        return q * y

    a = _A_ref(A_u, A_log_A_real, A_A_imag, A_C_real, A_C_imag, A_log_dt, A_D_skip)
    b = _B_ref(B_q, B_k, B_v, B_shift_k, B_ssm_k, B_ssm_D)
    return torch.concatenate([a, b], axis=-1)
```

```asm
; @launch grid=(256,1,1) block=(256,1,1) lds=127680
.amdgcn_target "amdgcn-amd-amdhsa--gfx950"
.text
.globl concat_heads__ssm_conv_s4d__ssm_conv_h3__prompt_kernel
.p2align 8
.type concat_heads__ssm_conv_s4d__ssm_conv_h3__prompt_kernel,@function
concat_heads__ssm_conv_s4d__ssm_conv_h3__prompt_kernel:
    s_cmp_ge_u32 s2, 256
    s_cbranch_scc1 L_end
    s_load_dwordx16 s[32:47], s[0:1], 0
    s_load_dwordx16 s[48:63], s[0:1], 64
    s_and_b32 s7, s2, 7
    s_lshr_b32 s24, s2, 3
    s_and_b32 s4, s24, 15
    s_lshl_b32 s4, s4, 2
    s_lshl_b32 s7, s7, 6
    s_add_u32 s4, s4, s7
    s_lshr_b32 s5, s24, 4
    v_lshrrev_b32 v1, 6, v0
    v_and_b32 v0, 63, v0
    s_nop 1
    v_readfirstlane_b32 s3, v1
    s_nop 3
    s_mul_i32 s6, s3, 25264
    s_lshl_b32 s7, s3, 9
    v_add_u32 v10, s7, v0
    v_lshlrev_b32 v1, 1, v10
    v_add_u32 v2, 50528, v1
    s_lshl_b32 s24, s4, 1
    v_lshlrev_b32 v8, 10, v10
    v_add_u32 v8, s24, v8
    v_and_b32 v11, 31, v0
    v_lshrrev_b32 v12, 5, v0
    v_and_b32 v13, 3, v0
    v_sub_u32 v13, 3, v13
    s_mov_b32 s7, 4418
    v_mul_lo_u32 v3, s7, v13
    v_lshlrev_b32 v14, 1, v11
    v_add_u32 v3, v3, v14
    v_lshlrev_b32 v14, 4, v12
    v_sub_u32 v3, v3, v14
    v_add_u32 v3, 26, v3
    v_add_u32 v3, s6, v3
    v_mul_u32_u24 v4, 80, v11
    v_add_u32 v4, v4, v14
    v_add_u32 v4, 17664, v4
    v_add_u32 v4, s6, v4
    v_mul_u32_u24 v5, 72, v11
    v_lshlrev_b32 v14, 3, v12
    v_add_u32 v5, v5, v14
    v_add_u32 v5, 17664, v5
    v_add_u32 v5, s6, v5
    s_lshl_b32 s7, s3, 4
    v_add_u32 v14, s7, v12
    v_mul_u32_u24 v6, 72, v14
    v_lshlrev_b32 v14, 1, v11
    v_add_u32 v6, v6, v14
    v_add_u32 v6, 17664, v6
    v_add_u32 v7, 50528, v6
    s_waitcnt lgkmcnt(0)
    s_mov_b32 s20, s58
    s_and_b32 s21, s59, 0xffff
    s_mov_b32 s22, 0x400000
    s_mov_b32 s23, 0x00020000
    s_cmp_eq_u32 s5, 0
    s_cbranch_scc1 L_A
L_B:
    s_mov_b32 s8, s48
    s_and_b32 s9, s49, 0xffff
    s_mov_b32 s10, 0x200000
    s_mov_b32 s11, 0x00020000
    s_mov_b32 s12, s50
    s_and_b32 s13, s51, 0xffff
    s_mov_b32 s14, 0x200000
    s_mov_b32 s15, 0x00020000
    s_mov_b32 s16, s54
    s_and_b32 s17, s55, 0xffff
    s_mov_b32 s18, 0x200000
    s_mov_b32 s19, 0x00020000
    s_lshl_b32 s7, s4, 3
    s_add_u32 s52, s52, s7
    s_addc_u32 s53, s53, 0
    s_load_dwordx8 s[84:91], s[52:53], 0
    s_lshl_b32 s7, s4, 1
    s_add_u32 s56, s56, s7
    s_addc_u32 s57, s57, 0
    s_load_dwordx2 s[92:93], s[56:57], 0
    s_mov_b32 s7, 0
    buffer_load_dwordx2 v[36:37], v8, s[8:11], s7 offen
    s_mov_b32 s7, 65536
    buffer_load_dwordx2 v[38:39], v8, s[8:11], s7 offen
    s_mov_b32 s7, 131072
    buffer_load_dwordx2 v[40:41], v8, s[8:11], s7 offen
    s_mov_b32 s7, 196608
    buffer_load_dwordx2 v[42:43], v8, s[8:11], s7 offen
    s_mov_b32 s7, 262144
    buffer_load_dwordx2 v[44:45], v8, s[8:11], s7 offen
    s_mov_b32 s7, 327680
    buffer_load_dwordx2 v[46:47], v8, s[8:11], s7 offen
    s_mov_b32 s7, 393216
    buffer_load_dwordx2 v[48:49], v8, s[8:11], s7 offen
    s_mov_b32 s7, 458752
    buffer_load_dwordx2 v[50:51], v8, s[8:11], s7 offen
    s_mov_b32 s7, 0
    buffer_load_dwordx2 v[52:53], v8, s[12:15], s7 offen
    s_mov_b32 s7, 65536
    buffer_load_dwordx2 v[54:55], v8, s[12:15], s7 offen
    s_mov_b32 s7, 131072
    buffer_load_dwordx2 v[56:57], v8, s[12:15], s7 offen
    s_mov_b32 s7, 196608
    buffer_load_dwordx2 v[58:59], v8, s[12:15], s7 offen
    s_mov_b32 s7, 262144
    buffer_load_dwordx2 v[60:61], v8, s[12:15], s7 offen
    s_mov_b32 s7, 327680
    buffer_load_dwordx2 v[62:63], v8, s[12:15], s7 offen
    s_mov_b32 s7, 393216
    buffer_load_dwordx2 v[64:65], v8, s[12:15], s7 offen
    s_mov_b32 s7, 458752
    buffer_load_dwordx2 v[66:67], v8, s[12:15], s7 offen
    s_add_u32 s7, s4, s3
    s_lshl_b32 s7, s7, 12
    v_lshlrev_b32 v10, 4, v0
    v_add_u32 v10, s7, v10
    buffer_load_dwordx4 v[100:103], v10, s[16:19], 0 offen offset:0
    buffer_load_dwordx4 v[104:107], v10, s[16:19], 0 offen offset:1024
    buffer_load_dwordx4 v[108:111], v10, s[16:19], 0 offen offset:2048
    buffer_load_dwordx4 v[112:115], v10, s[16:19], 0 offen offset:3072
    v_mov_b32 v10, 0
    v_mov_b32 v11, 0
    v_mov_b32 v12, 0
    v_mov_b32 v13, 0
    v_lshlrev_b32 v14, 4, v0
    v_add_u32 v14, s6, v14
    ds_write_b128 v14, v[10:13] offset:17664
    ds_write_b128 v14, v[10:13] offset:18688
    ds_write_b128 v14, v[10:13] offset:19712
    v_mov_b32 v15, 0x33333334
    v_mul_hi_u32 v15, v15, v0
    v_mul_u32_u24 v16, 5, v15
    v_sub_u32 v16, v0, v16
    v_mul_u32_u24 v15, 4416, v15
    v_lshlrev_b32 v16, 4, v16
    v_add3_u32 v15, v15, v16, s6
    v_cmp_gt_u32 vcc, 20, v0
    s_and_saveexec_b64 s[26:27], vcc
    ds_write_b128 v15, v[10:13] offset:0
    s_mov_b64 exec, s[26:27]
    s_waitcnt lgkmcnt(0)
    s_lshl_b32 s64, s84, 16
    s_and_b32 s65, s84, 0xffff0000
    s_lshl_b32 s66, s85, 16
    s_and_b32 s67, s85, 0xffff0000
    s_lshl_b32 s68, s86, 16
    s_and_b32 s69, s86, 0xffff0000
    s_lshl_b32 s70, s87, 16
    s_and_b32 s71, s87, 0xffff0000
    s_lshl_b32 s72, s88, 16
    s_and_b32 s73, s88, 0xffff0000
    s_lshl_b32 s74, s89, 16
    s_and_b32 s75, s89, 0xffff0000
    s_lshl_b32 s76, s90, 16
    s_and_b32 s77, s90, 0xffff0000
    s_lshl_b32 s78, s91, 16
    s_and_b32 s79, s91, 0xffff0000
    s_lshl_b32 s80, s92, 16
    s_and_b32 s81, s92, 0xffff0000
    s_lshl_b32 s82, s93, 16
    s_and_b32 s83, s93, 0xffff0000
    v_lshlrev_b32 v18, 2, v1
    v_add_u32 v18, 101056, v18
    s_waitcnt vmcnt(19)
    ds_write_b64 v18, v[36:37] offset:24
    s_waitcnt vmcnt(18)
    ds_write_b64 v18, v[38:39] offset:536
    s_waitcnt vmcnt(17)
    ds_write_b64 v18, v[40:41] offset:1048
    s_waitcnt vmcnt(16)
    ds_write_b64 v18, v[42:43] offset:1560
    s_waitcnt vmcnt(15)
    ds_write_b64 v18, v[44:45] offset:2072
    s_waitcnt vmcnt(14)
    ds_write_b64 v18, v[46:47] offset:2584
    s_waitcnt vmcnt(13)
    ds_write_b64 v18, v[48:49] offset:3096
    s_waitcnt vmcnt(12)
    ds_write_b64 v18, v[50:51] offset:3608
    v_mov_b32 v10, 0
    v_mov_b32 v11, 0
    v_lshlrev_b32 v12, 3, v0
    v_add_u32 v12, 101056, v12
    s_cmp_eq_u32 s3, 0
    s_cbranch_scc0 L_B_nz
    v_cmp_gt_u32 vcc, 3, v0
    s_and_saveexec_b64 s[26:27], vcc
    ds_write_b64 v12, v[10:11]
    s_mov_b64 exec, s[26:27]
L_B_nz:
    s_waitcnt vmcnt(0)
    v_lshrrev_b32 v12, 2, v0
    v_mul_u32_u24 v12, 80, v12
    v_and_b32 v13, 3, v0
    v_lshlrev_b32 v13, 4, v13
    v_add3_u32 v12, v12, v13, s6
    v_alignbit_b32 v14, v103, v103, 16
    v_alignbit_b32 v15, v102, v102, 16
    v_alignbit_b32 v16, v101, v101, 16
    v_alignbit_b32 v17, v100, v100, 16
    ds_write_b128 v12, v[14:17] offset:20144
    v_alignbit_b32 v14, v107, v107, 16
    v_alignbit_b32 v15, v106, v106, 16
    v_alignbit_b32 v16, v105, v105, 16
    v_alignbit_b32 v17, v104, v104, 16
    ds_write_b128 v12, v[14:17] offset:21424
    v_alignbit_b32 v14, v111, v111, 16
    v_alignbit_b32 v15, v110, v110, 16
    v_alignbit_b32 v16, v109, v109, 16
    v_alignbit_b32 v17, v108, v108, 16
    ds_write_b128 v12, v[14:17] offset:22704
    v_alignbit_b32 v14, v115, v115, 16
    v_alignbit_b32 v15, v114, v114, 16
    v_alignbit_b32 v16, v113, v113, 16
    v_alignbit_b32 v17, v112, v112, 16
    ds_write_b128 v12, v[14:17] offset:23984
    s_waitcnt lgkmcnt(0)
    s_barrier
    ds_read_b64 v[10:11], v18 offset:16
    ds_read_b64 v[12:13], v18 offset:8
    ds_read_b64 v[14:15], v18 offset:0
    s_waitcnt lgkmcnt(0)
    v_lshlrev_b32 v24, 16, v14
    v_and_b32 v25, 0xffff0000, v14
    v_lshlrev_b32 v26, 16, v15
    v_and_b32 v27, 0xffff0000, v15
    v_mul_f32 v24, s67, v24
    v_mul_f32 v25, s71, v25
    v_mul_f32 v26, s75, v26
    v_mul_f32 v27, s79, v27
    v_cvt_pk_bf16_f32 v30, v24, v25
    v_cvt_pk_bf16_f32 v31, v26, v27
    v_lshlrev_b32 v24, 16, v30
    v_and_b32 v25, 0xffff0000, v30
    v_lshlrev_b32 v26, 16, v31
    v_and_b32 v27, 0xffff0000, v31
    v_mov_b32 v20, v24
    v_mov_b32 v21, v25
    v_mov_b32 v22, v26
    v_mov_b32 v23, v27
    v_lshlrev_b32 v24, 16, v12
    v_and_b32 v25, 0xffff0000, v12
    v_lshlrev_b32 v26, 16, v13
    v_and_b32 v27, 0xffff0000, v13
    v_mul_f32 v24, s66, v24
    v_mul_f32 v25, s70, v25
    v_mul_f32 v26, s74, v26
    v_mul_f32 v27, s78, v27
    v_cvt_pk_bf16_f32 v30, v24, v25
    v_cvt_pk_bf16_f32 v31, v26, v27
    v_lshlrev_b32 v24, 16, v30
    v_and_b32 v25, 0xffff0000, v30
    v_lshlrev_b32 v26, 16, v31
    v_and_b32 v27, 0xffff0000, v31
    v_add_f32 v20, v20, v24
    v_add_f32 v21, v21, v25
    v_add_f32 v22, v22, v26
    v_add_f32 v23, v23, v27
    v_cvt_pk_bf16_f32 v30, v20, v21
    v_cvt_pk_bf16_f32 v31, v22, v23
    v_lshlrev_b32 v20, 16, v30
    v_and_b32 v21, 0xffff0000, v30
    v_lshlrev_b32 v22, 16, v31
    v_and_b32 v23, 0xffff0000, v31
    v_lshlrev_b32 v24, 16, v10
    v_and_b32 v25, 0xffff0000, v10
    v_lshlrev_b32 v26, 16, v11
    v_and_b32 v27, 0xffff0000, v11
    v_mul_f32 v24, s65, v24
    v_mul_f32 v25, s69, v25
    v_mul_f32 v26, s73, v26
    v_mul_f32 v27, s77, v27
    v_cvt_pk_bf16_f32 v30, v24, v25
    v_cvt_pk_bf16_f32 v31, v26, v27
    v_lshlrev_b32 v24, 16, v30
    v_and_b32 v25, 0xffff0000, v30
    v_lshlrev_b32 v26, 16, v31
    v_and_b32 v27, 0xffff0000, v31
    v_add_f32 v20, v20, v24
    v_add_f32 v21, v21, v25
    v_add_f32 v22, v22, v26
    v_add_f32 v23, v23, v27
    v_cvt_pk_bf16_f32 v30, v20, v21
    v_cvt_pk_bf16_f32 v31, v22, v23
    v_lshlrev_b32 v20, 16, v30
    v_and_b32 v21, 0xffff0000, v30
    v_lshlrev_b32 v22, 16, v31
    v_and_b32 v23, 0xffff0000, v31
    v_lshlrev_b32 v24, 16, v36
    v_and_b32 v25, 0xffff0000, v36
    v_lshlrev_b32 v26, 16, v37
    v_and_b32 v27, 0xffff0000, v37
    v_mul_f32 v24, s64, v24
    v_mul_f32 v25, s68, v25
    v_mul_f32 v26, s72, v26
    v_mul_f32 v27, s76, v27
    v_cvt_pk_bf16_f32 v30, v24, v25
    v_cvt_pk_bf16_f32 v31, v26, v27
    v_lshlrev_b32 v24, 16, v30
    v_and_b32 v25, 0xffff0000, v30
    v_lshlrev_b32 v26, 16, v31
    v_and_b32 v27, 0xffff0000, v31
    v_add_f32 v20, v20, v24
    v_add_f32 v21, v21, v25
    v_add_f32 v22, v22, v26
    v_add_f32 v23, v23, v27
    v_cvt_pk_bf16_f32 v30, v20, v21
    v_cvt_pk_bf16_f32 v31, v22, v23
    v_lshlrev_b32 v20, 16, v30
    v_and_b32 v21, 0xffff0000, v30
    v_lshlrev_b32 v22, 16, v31
    v_and_b32 v23, 0xffff0000, v31
    v_lshlrev_b32 v24, 16, v52
    v_and_b32 v25, 0xffff0000, v52
    v_lshlrev_b32 v26, 16, v53
    v_and_b32 v27, 0xffff0000, v53
    v_mul_f32 v20, v20, v24
    v_mul_f32 v21, v21, v25
    v_mul_f32 v22, v22, v26
    v_mul_f32 v23, v23, v27
    v_cvt_pk_bf16_f32 v36, v20, v21
    v_cvt_pk_bf16_f32 v37, v22, v23
    ds_write_b16 v1, v36 offset:72
    ds_write_b16 v1, v36 offset:4490
    ds_write_b16 v1, v36 offset:8908
    ds_write_b16 v1, v36 offset:13326
    ds_write_b16_d16_hi v1, v36 offset:25336
    ds_write_b16_d16_hi v1, v36 offset:29754
    ds_write_b16_d16_hi v1, v36 offset:34172
    ds_write_b16_d16_hi v1, v36 offset:38590
    ds_write_b16 v2, v37 offset:72
    ds_write_b16 v2, v37 offset:4490
    ds_write_b16 v2, v37 offset:8908
    ds_write_b16 v2, v37 offset:13326
    ds_write_b16_d16_hi v2, v37 offset:25336
    ds_write_b16_d16_hi v2, v37 offset:29754
    ds_write_b16_d16_hi v2, v37 offset:34172
    ds_write_b16_d16_hi v2, v37 offset:38590
    ds_read_b64 v[10:11], v18 offset:528
    ds_read_b64 v[12:13], v18 offset:520
    ds_read_b64 v[14:15], v18 offset:512
    s_waitcnt lgkmcnt(0)
    v_lshlrev_b32 v24, 16, v14
    v_and_b32 v25, 0xffff0000, v14
    v_lshlrev_b32 v26, 16, v15
    v_and_b32 v27, 0xffff0000, v15
    v_mul_f32 v24, s67, v24
    v_mul_f32 v25, s71, v25
    v_mul_f32 v26, s75, v26
    v_mul_f32 v27, s79, v27
    v_cvt_pk_bf16_f32 v30, v24, v25
    v_cvt_pk_bf16_f32 v31, v26, v27
    v_lshlrev_b32 v24, 16, v30
    v_and_b32 v25, 0xffff0000, v30
    v_lshlrev_b32 v26, 16, v31
    v_and_b32 v27, 0xffff0000, v31
    v_mov_b32 v20, v24
    v_mov_b32 v21, v25
    v_mov_b32 v22, v26
    v_mov_b32 v23, v27
    v_lshlrev_b32 v24, 16, v12
    v_and_b32 v25, 0xffff0000, v12
    v_lshlrev_b32 v26, 16, v13
    v_and_b32 v27, 0xffff0000, v13
    v_mul_f32 v24, s66, v24
    v_mul_f32 v25, s70, v25
    v_mul_f32 v26, s74, v26
    v_mul_f32 v27, s78, v27
    v_cvt_pk_bf16_f32 v30, v24, v25
    v_cvt_pk_bf16_f32 v31, v26, v27
    v_lshlrev_b32 v24, 16, v30
    v_and_b32 v25, 0xffff0000, v30
    v_lshlrev_b32 v26, 16, v31
    v_and_b32 v27, 0xffff0000, v31
    v_add_f32 v20, v20, v24
    v_add_f32 v21, v21, v25
    v_add_f32 v22, v22, v26
    v_add_f32 v23, v23, v27
    v_cvt_pk_bf16_f32 v30, v20, v21
    v_cvt_pk_bf16_f32 v31, v22, v23
    v_lshlrev_b32 v20, 16, v30
    v_and_b32 v21, 0xffff0000, v30
    v_lshlrev_b32 v22, 16, v31
    v_and_b32 v23, 0xffff0000, v31
    v_lshlrev_b32 v24, 16, v10
    v_and_b32 v25, 0xffff0000, v10
    v_lshlrev_b32 v26, 16, v11
    v_and_b32 v27, 0xffff0000, v11
    v_mul_f32 v24, s65, v24
    v_mul_f32 v25, s69, v25
    v_mul_f32 v26, s73, v26
    v_mul_f32 v27, s77, v27
    v_cvt_pk_bf16_f32 v30, v24, v25
    v_cvt_pk_bf16_f32 v31, v26, v27
    v_lshlrev_b32 v24, 16, v30
    v_and_b32 v25, 0xffff0000, v30
    v_lshlrev_b32 v26, 16, v31
    v_and_b32 v27, 0xffff0000, v31
    v_add_f32 v20, v20, v24
    v_add_f32 v21, v21, v25
    v_add_f32 v22, v22, v26
    v_add_f32 v23, v23, v27
    v_cvt_pk_bf16_f32 v30, v20, v21
    v_cvt_pk_bf16_f32 v31, v22, v23
    v_lshlrev_b32 v20, 16, v30
    v_and_b32 v21, 0xffff0000, v30
    v_lshlrev_b32 v22, 16, v31
    v_and_b32 v23, 0xffff0000, v31
    v_lshlrev_b32 v24, 16, v38
    v_and_b32 v25, 0xffff0000, v38
    v_lshlrev_b32 v26, 16, v39
    v_and_b32 v27, 0xffff0000, v39
    v_mul_f32 v24, s64, v24
    v_mul_f32 v25, s68, v25
    v_mul_f32 v26, s72, v26
    v_mul_f32 v27, s76, v27
    v_cvt_pk_bf16_f32 v30, v24, v25
    v_cvt_pk_bf16_f32 v31, v26, v27
    v_lshlrev_b32 v24, 16, v30
    v_and_b32 v25, 0xffff0000, v30
    v_lshlrev_b32 v26, 16, v31
    v_and_b32 v27, 0xffff0000, v31
    v_add_f32 v20, v20, v24
    v_add_f32 v21, v21, v25
    v_add_f32 v22, v22, v26
    v_add_f32 v23, v23, v27
    v_cvt_pk_bf16_f32 v30, v20, v21
    v_cvt_pk_bf16_f32 v31, v22, v23
    v_lshlrev_b32 v20, 16, v30
    v_and_b32 v21, 0xffff0000, v30
    v_lshlrev_b32 v22, 16, v31
    v_and_b32 v23, 0xffff0000, v31
    v_lshlrev_b32 v24, 16, v54
    v_and_b32 v25, 0xffff0000, v54
    v_lshlrev_b32 v26, 16, v55
    v_and_b32 v27, 0xffff0000, v55
    v_mul_f32 v20, v20, v24
    v_mul_f32 v21, v21, v25
    v_mul_f32 v22, v22, v26
    v_mul_f32 v23, v23, v27
    v_cvt_pk_bf16_f32 v38, v20, v21
    v_cvt_pk_bf16_f32 v39, v22, v23
    ds_write_b16 v1, v38 offset:200
    ds_write_b16 v1, v38 offset:4618
    ds_write_b16 v1, v38 offset:9036
    ds_write_b16 v1, v38 offset:13454
    ds_write_b16_d16_hi v1, v38 offset:25464
    ds_write_b16_d16_hi v1, v38 offset:29882
    ds_write_b16_d16_hi v1, v38 offset:34300
    ds_write_b16_d16_hi v1, v38 offset:38718
    ds_write_b16 v2, v39 offset:200
    ds_write_b16 v2, v39 offset:4618
    ds_write_b16 v2, v39 offset:9036
    ds_write_b16 v2, v39 offset:13454
    ds_write_b16_d16_hi v2, v39 offset:25464
    ds_write_b16_d16_hi v2, v39 offset:29882
    ds_write_b16_d16_hi v2, v39 offset:34300
    ds_write_b16_d16_hi v2, v39 offset:38718
    ds_read_b64 v[10:11], v18 offset:1040
    ds_read_b64 v[12:13], v18 offset:1032
    ds_read_b64 v[14:15], v18 offset:1024
    s_waitcnt lgkmcnt(0)
    v_lshlrev_b32 v24, 16, v14
    v_and_b32 v25, 0xffff0000, v14
    v_lshlrev_b32 v26, 16, v15
    v_and_b32 v27, 0xffff0000, v15
    v_mul_f32 v24, s67, v24
    v_mul_f32 v25, s71, v25
    v_mul_f32 v26, s75, v26
    v_mul_f32 v27, s79, v27
    v_cvt_pk_bf16_f32 v30, v24, v25
    v_cvt_pk_bf16_f32 v31, v26, v27
    v_lshlrev_b32 v24, 16, v30
    v_and_b32 v25, 0xffff0000, v30
    v_lshlrev_b32 v26, 16, v31
    v_and_b32 v27, 0xffff0000, v31
    v_mov_b32 v20, v24
    v_mov_b32 v21, v25
    v_mov_b32 v22, v26
    v_mov_b32 v23, v27
    v_lshlrev_b32 v24, 16, v12
    v_and_b32 v25, 0xffff0000, v12
    v_lshlrev_b32 v26, 16, v13
    v_and_b32 v27, 0xffff0000, v13
    v_mul_f32 v24, s66, v24
    v_mul_f32 v25, s70, v25
    v_mul_f32 v26, s74, v26
    v_mul_f32 v27, s78, v27
    v_cvt_pk_bf16_f32 v30, v24, v25
    v_cvt_pk_bf16_f32 v31, v26, v27
    v_lshlrev_b32 v24, 16, v30
    v_and_b32 v25, 0xffff0000, v30
    v_lshlrev_b32 v26, 16, v31
    v_and_b32 v27, 0xffff0000, v31
    v_add_f32 v20, v20, v24
    v_add_f32 v21, v21, v25
    v_add_f32 v22, v22, v26
    v_add_f32 v23, v23, v27
    v_cvt_pk_bf16_f32 v30, v20, v21
    v_cvt_pk_bf16_f32 v31, v22, v23
    v_lshlrev_b32 v20, 16, v30
    v_and_b32 v21, 0xffff0000, v30
    v_lshlrev_b32 v22, 16, v31
    v_and_b32 v23, 0xffff0000, v31
    v_lshlrev_b32 v24, 16, v10
    v_and_b32 v25, 0xffff0000, v10
    v_lshlrev_b32 v26, 16, v11
    v_and_b32 v27, 0xffff0000, v11
    v_mul_f32 v24, s65, v24
    v_mul_f32 v25, s69, v25
    v_mul_f32 v26, s73, v26
    v_mul_f32 v27, s77, v27
    v_cvt_pk_bf16_f32 v30, v24, v25
    v_cvt_pk_bf16_f32 v31, v26, v27
    v_lshlrev_b32 v24, 16, v30
    v_and_b32 v25, 0xffff0000, v30
    v_lshlrev_b32 v26, 16, v31
    v_and_b32 v27, 0xffff0000, v31
    v_add_f32 v20, v20, v24
    v_add_f32 v21, v21, v25
    v_add_f32 v22, v22, v26
    v_add_f32 v23, v23, v27
    v_cvt_pk_bf16_f32 v30, v20, v21
    v_cvt_pk_bf16_f32 v31, v22, v23
    v_lshlrev_b32 v20, 16, v30
    v_and_b32 v21, 0xffff0000, v30
    v_lshlrev_b32 v22, 16, v31
    v_and_b32 v23, 0xffff0000, v31
    v_lshlrev_b32 v24, 16, v40
    v_and_b32 v25, 0xffff0000, v40
    v_lshlrev_b32 v26, 16, v41
    v_and_b32 v27, 0xffff0000, v41
    v_mul_f32 v24, s64, v24
    v_mul_f32 v25, s68, v25
    v_mul_f32 v26, s72, v26
    v_mul_f32 v27, s76, v27
    v_cvt_pk_bf16_f32 v30, v24, v25
    v_cvt_pk_bf16_f32 v31, v26, v27
    v_lshlrev_b32 v24, 16, v30
    v_and_b32 v25, 0xffff0000, v30
    v_lshlrev_b32 v26, 16, v31
    v_and_b32 v27, 0xffff0000, v31
    v_add_f32 v20, v20, v24
    v_add_f32 v21, v21, v25
    v_add_f32 v22, v22, v26
    v_add_f32 v23, v23, v27
    v_cvt_pk_bf16_f32 v30, v20, v21
    v_cvt_pk_bf16_f32 v31, v22, v23
    v_lshlrev_b32 v20, 16, v30
    v_and_b32 v21, 0xffff0000, v30
    v_lshlrev_b32 v22, 16, v31
    v_and_b32 v23, 0xffff0000, v31
    v_lshlrev_b32 v24, 16, v56
    v_and_b32 v25, 0xffff0000, v56
    v_lshlrev_b32 v26, 16, v57
    v_and_b32 v27, 0xffff0000, v57
    v_mul_f32 v20, v20, v24
    v_mul_f32 v21, v21, v25
    v_mul_f32 v22, v22, v26
    v_mul_f32 v23, v23, v27
    v_cvt_pk_bf16_f32 v40, v20, v21
    v_cvt_pk_bf16_f32 v41, v22, v23
    ds_write_b16 v1, v40 offset:328
    ds_write_b16 v1, v40 offset:4746
    ds_write_b16 v1, v40 offset:9164
    ds_write_b16 v1, v40 offset:13582
    ds_write_b16_d16_hi v1, v40 offset:25592
    ds_write_b16_d16_hi v1, v40 offset:30010
    ds_write_b16_d16_hi v1, v40 offset:34428
    ds_write_b16_d16_hi v1, v40 offset:38846
    ds_write_b16 v2, v41 offset:328
    ds_write_b16 v2, v41 offset:4746
    ds_write_b16 v2, v41 offset:9164
    ds_write_b16 v2, v41 offset:13582
    ds_write_b16_d16_hi v2, v41 offset:25592
    ds_write_b16_d16_hi v2, v41 offset:30010
    ds_write_b16_d16_hi v2, v41 offset:34428
    ds_write_b16_d16_hi v2, v41 offset:38846
    ds_read_b64 v[10:11], v18 offset:1552
    ds_read_b64 v[12:13], v18 offset:1544
    ds_read_b64 v[14:15], v18 offset:1536
    s_waitcnt lgkmcnt(0)
    v_lshlrev_b32 v24, 16, v14
    v_and_b32 v25, 0xffff0000, v14
    v_lshlrev_b32 v26, 16, v15
    v_and_b32 v27, 0xffff0000, v15
    v_mul_f32 v24, s67, v24
    v_mul_f32 v25, s71, v25
    v_mul_f32 v26, s75, v26
    v_mul_f32 v27, s79, v27
    v_cvt_pk_bf16_f32 v30, v24, v25
    v_cvt_pk_bf16_f32 v31, v26, v27
    v_lshlrev_b32 v24, 16, v30
    v_and_b32 v25, 0xffff0000, v30
    v_lshlrev_b32 v26, 16, v31
    v_and_b32 v27, 0xffff0000, v31
    v_mov_b32 v20, v24
    v_mov_b32 v21, v25
    v_mov_b32 v22, v26
    v_mov_b32 v23, v27
    v_lshlrev_b32 v24, 16, v12
    v_and_b32 v25, 0xffff0000, v12
    v_lshlrev_b32 v26, 16, v13
    v_and_b32 v27, 0xffff0000, v13
    v_mul_f32 v24, s66, v24
    v_mul_f32 v25, s70, v25
    v_mul_f32 v26, s74, v26
    v_mul_f32 v27, s78, v27
    v_cvt_pk_bf16_f32 v30, v24, v25
    v_cvt_pk_bf16_f32 v31, v26, v27
    v_lshlrev_b32 v24, 16, v30
    v_and_b32 v25, 0xffff0000, v30
    v_lshlrev_b32 v26, 16, v31
    v_and_b32 v27, 0xffff0000, v31
    v_add_f32 v20, v20, v24
    v_add_f32 v21, v21, v25
    v_add_f32 v22, v22, v26
    v_add_f32 v23, v23, v27
    v_cvt_pk_bf16_f32 v30, v20, v21
    v_cvt_pk_bf16_f32 v31, v22, v23
    v_lshlrev_b32 v20, 16, v30
    v_and_b32 v21, 0xffff0000, v30
    v_lshlrev_b32 v22, 16, v31
    v_and_b32 v23, 0xffff0000, v31
    v_lshlrev_b32 v24, 16, v10
    v_and_b32 v25, 0xffff0000, v10
    v_lshlrev_b32 v26, 16, v11
    v_and_b32 v27, 0xffff0000, v11
    v_mul_f32 v24, s65, v24
    v_mul_f32 v25, s69, v25
    v_mul_f32 v26, s73, v26
    v_mul_f32 v27, s77, v27
    v_cvt_pk_bf16_f32 v30, v24, v25
    v_cvt_pk_bf16_f32 v31, v26, v27
    v_lshlrev_b32 v24, 16, v30
    v_and_b32 v25, 0xffff0000, v30
    v_lshlrev_b32 v26, 16, v31
    v_and_b32 v27, 0xffff0000, v31
    v_add_f32 v20, v20, v24
    v_add_f32 v21, v21, v25
    v_add_f32 v22, v22, v26
    v_add_f32 v23, v23, v27
    v_cvt_pk_bf16_f32 v30, v20, v21
    v_cvt_pk_bf16_f32 v31, v22, v23
    v_lshlrev_b32 v20, 16, v30
    v_and_b32 v21, 0xffff0000, v30
    v_lshlrev_b32 v22, 16, v31
    v_and_b32 v23, 0xffff0000, v31
    v_lshlrev_b32 v24, 16, v42
    v_and_b32 v25, 0xffff0000, v42
    v_lshlrev_b32 v26, 16, v43
    v_and_b32 v27, 0xffff0000, v43
    v_mul_f32 v24, s64, v24
    v_mul_f32 v25, s68, v25
    v_mul_f32 v26, s72, v26
    v_mul_f32 v27, s76, v27
    v_cvt_pk_bf16_f32 v30, v24, v25
    v_cvt_pk_bf16_f32 v31, v26, v27
    v_lshlrev_b32 v24, 16, v30
    v_and_b32 v25, 0xffff0000, v30
    v_lshlrev_b32 v26, 16, v31
    v_and_b32 v27, 0xffff0000, v31
    v_add_f32 v20, v20, v24
    v_add_f32 v21, v21, v25
    v_add_f32 v22, v22, v26
    v_add_f32 v23, v23, v27
    v_cvt_pk_bf16_f32 v30, v20, v21
    v_cvt_pk_bf16_f32 v31, v22, v23
    v_lshlrev_b32 v20, 16, v30
    v_and_b32 v21, 0xffff0000, v30
    v_lshlrev_b32 v22, 16, v31
    v_and_b32 v23, 0xffff0000, v31
    v_lshlrev_b32 v24, 16, v58
    v_and_b32 v25, 0xffff0000, v58
    v_lshlrev_b32 v26, 16, v59
    v_and_b32 v27, 0xffff0000, v59
    v_mul_f32 v20, v20, v24
    v_mul_f32 v21, v21, v25
    v_mul_f32 v22, v22, v26
    v_mul_f32 v23, v23, v27
    v_cvt_pk_bf16_f32 v42, v20, v21
    v_cvt_pk_bf16_f32 v43, v22, v23
    ds_write_b16 v1, v42 offset:456
    ds_write_b16 v1, v42 offset:4874
    ds_write_b16 v1, v42 offset:9292
    ds_write_b16 v1, v42 offset:13710
    ds_write_b16_d16_hi v1, v42 offset:25720
    ds_write_b16_d16_hi v1, v42 offset:30138
    ds_write_b16_d16_hi v1, v42 offset:34556
    ds_write_b16_d16_hi v1, v42 offset:38974
    ds_write_b16 v2, v43 offset:456
    ds_write_b16 v2, v43 offset:4874
    ds_write_b16 v2, v43 offset:9292
    ds_write_b16 v2, v43 offset:13710
    ds_write_b16_d16_hi v2, v43 offset:25720
    ds_write_b16_d16_hi v2, v43 offset:30138
    ds_write_b16_d16_hi v2, v43 offset:34556
    ds_write_b16_d16_hi v2, v43 offset:38974
    ds_read_b64 v[10:11], v18 offset:2064
    ds_read_b64 v[12:13], v18 offset:2056
    ds_read_b64 v[14:15], v18 offset:2048
    s_waitcnt lgkmcnt(0)
    v_lshlrev_b32 v24, 16, v14
    v_and_b32 v25, 0xffff0000, v14
    v_lshlrev_b32 v26, 16, v15
    v_and_b32 v27, 0xffff0000, v15
    v_mul_f32 v24, s67, v24
    v_mul_f32 v25, s71, v25
    v_mul_f32 v26, s75, v26
    v_mul_f32 v27, s79, v27
    v_cvt_pk_bf16_f32 v30, v24, v25
    v_cvt_pk_bf16_f32 v31, v26, v27
    v_lshlrev_b32 v24, 16, v30
    v_and_b32 v25, 0xffff0000, v30
    v_lshlrev_b32 v26, 16, v31
    v_and_b32 v27, 0xffff0000, v31
    v_mov_b32 v20, v24
    v_mov_b32 v21, v25
    v_mov_b32 v22, v26
    v_mov_b32 v23, v27
    v_lshlrev_b32 v24, 16, v12
    v_and_b32 v25, 0xffff0000, v12
    v_lshlrev_b32 v26, 16, v13
    v_and_b32 v27, 0xffff0000, v13
    v_mul_f32 v24, s66, v24
    v_mul_f32 v25, s70, v25
    v_mul_f32 v26, s74, v26
    v_mul_f32 v27, s78, v27
    v_cvt_pk_bf16_f32 v30, v24, v25
    v_cvt_pk_bf16_f32 v31, v26, v27
    v_lshlrev_b32 v24, 16, v30
    v_and_b32 v25, 0xffff0000, v30
    v_lshlrev_b32 v26, 16, v31
    v_and_b32 v27, 0xffff0000, v31
    v_add_f32 v20, v20, v24
    v_add_f32 v21, v21, v25
    v_add_f32 v22, v22, v26
    v_add_f32 v23, v23, v27
    v_cvt_pk_bf16_f32 v30, v20, v21
    v_cvt_pk_bf16_f32 v31, v22, v23
    v_lshlrev_b32 v20, 16, v30
    v_and_b32 v21, 0xffff0000, v30
    v_lshlrev_b32 v22, 16, v31
    v_and_b32 v23, 0xffff0000, v31
    v_lshlrev_b32 v24, 16, v10
    v_and_b32 v25, 0xffff0000, v10
    v_lshlrev_b32 v26, 16, v11
    v_and_b32 v27, 0xffff0000, v11
    v_mul_f32 v24, s65, v24
    v_mul_f32 v25, s69, v25
    v_mul_f32 v26, s73, v26
    v_mul_f32 v27, s77, v27
    v_cvt_pk_bf16_f32 v30, v24, v25
    v_cvt_pk_bf16_f32 v31, v26, v27
    v_lshlrev_b32 v24, 16, v30
    v_and_b32 v25, 0xffff0000, v30
    v_lshlrev_b32 v26, 16, v31
    v_and_b32 v27, 0xffff0000, v31
    v_add_f32 v20, v20, v24
    v_add_f32 v21, v21, v25
    v_add_f32 v22, v22, v26
    v_add_f32 v23, v23, v27
    v_cvt_pk_bf16_f32 v30, v20, v21
    v_cvt_pk_bf16_f32 v31, v22, v23
    v_lshlrev_b32 v20, 16, v30
    v_and_b32 v21, 0xffff0000, v30
    v_lshlrev_b32 v22, 16, v31
    v_and_b32 v23, 0xffff0000, v31
    v_lshlrev_b32 v24, 16, v44
    v_and_b32 v25, 0xffff0000, v44
    v_lshlrev_b32 v26, 16, v45
    v_and_b32 v27, 0xffff0000, v45
    v_mul_f32 v24, s64, v24
    v_mul_f32 v25, s68, v25
    v_mul_f32 v26, s72, v26
    v_mul_f32 v27, s76, v27
    v_cvt_pk_bf16_f32 v30, v24, v25
    v_cvt_pk_bf16_f32 v31, v26, v27
    v_lshlrev_b32 v24, 16, v30
    v_and_b32 v25, 0xffff0000, v30
    v_lshlrev_b32 v26, 16, v31
    v_and_b32 v27, 0xffff0000, v31
    v_add_f32 v20, v20, v24
    v_add_f32 v21, v21, v25
    v_add_f32 v22, v22, v26
    v_add_f32 v23, v23, v27
    v_cvt_pk_bf16_f32 v30, v20, v21
    v_cvt_pk_bf16_f32 v31, v22, v23
    v_lshlrev_b32 v20, 16, v30
    v_and_b32 v21, 0xffff0000, v30
    v_lshlrev_b32 v22, 16, v31
    v_and_b32 v23, 0xffff0000, v31
    v_lshlrev_b32 v24, 16, v60
    v_and_b32 v25, 0xffff0000, v60
    v_lshlrev_b32 v26, 16, v61
    v_and_b32 v27, 0xffff0000, v61
    v_mul_f32 v20, v20, v24
    v_mul_f32 v21, v21, v25
    v_mul_f32 v22, v22, v26
    v_mul_f32 v23, v23, v27
    v_cvt_pk_bf16_f32 v44, v20, v21
    v_cvt_pk_bf16_f32 v45, v22, v23
    ds_write_b16 v1, v44 offset:584
    ds_write_b16 v1, v44 offset:5002
    ds_write_b16 v1, v44 offset:9420
    ds_write_b16 v1, v44 offset:13838
    ds_write_b16_d16_hi v1, v44 offset:25848
    ds_write_b16_d16_hi v1, v44 offset:30266
    ds_write_b16_d16_hi v1, v44 offset:34684
    ds_write_b16_d16_hi v1, v44 offset:39102
    ds_write_b16 v2, v45 offset:584
    ds_write_b16 v2, v45 offset:5002
    ds_write_b16 v2, v45 offset:9420
    ds_write_b16 v2, v45 offset:13838
    ds_write_b16_d16_hi v2, v45 offset:25848
    ds_write_b16_d16_hi v2, v45 offset:30266
    ds_write_b16_d16_hi v2, v45 offset:34684
    ds_write_b16_d16_hi v2, v45 offset:39102
    ds_read_b64 v[10:11], v18 offset:2576
    ds_read_b64 v[12:13], v18 offset:2568
    ds_read_b64 v[14:15], v18 offset:2560
    s_waitcnt lgkmcnt(0)
    v_lshlrev_b32 v24, 16, v14
    v_and_b32 v25, 0xffff0000, v14
    v_lshlrev_b32 v26, 16, v15
    v_and_b32 v27, 0xffff0000, v15
    v_mul_f32 v24, s67, v24
    v_mul_f32 v25, s71, v25
    v_mul_f32 v26, s75, v26
    v_mul_f32 v27, s79, v27
    v_cvt_pk_bf16_f32 v30, v24, v25
    v_cvt_pk_bf16_f32 v31, v26, v27
    v_lshlrev_b32 v24, 16, v30
    v_and_b32 v25, 0xffff0000, v30
    v_lshlrev_b32 v26, 16, v31
    v_and_b32 v27, 0xffff0000, v31
    v_mov_b32 v20, v24
    v_mov_b32 v21, v25
    v_mov_b32 v22, v26
    v_mov_b32 v23, v27
    v_lshlrev_b32 v24, 16, v12
    v_and_b32 v25, 0xffff0000, v12
    v_lshlrev_b32 v26, 16, v13
    v_and_b32 v27, 0xffff0000, v13
    v_mul_f32 v24, s66, v24
    v_mul_f32 v25, s70, v25
    v_mul_f32 v26, s74, v26
    v_mul_f32 v27, s78, v27
    v_cvt_pk_bf16_f32 v30, v24, v25
    v_cvt_pk_bf16_f32 v31, v26, v27
    v_lshlrev_b32 v24, 16, v30
    v_and_b32 v25, 0xffff0000, v30
    v_lshlrev_b32 v26, 16, v31
    v_and_b32 v27, 0xffff0000, v31
    v_add_f32 v20, v20, v24
    v_add_f32 v21, v21, v25
    v_add_f32 v22, v22, v26
    v_add_f32 v23, v23, v27
    v_cvt_pk_bf16_f32 v30, v20, v21
    v_cvt_pk_bf16_f32 v31, v22, v23
    v_lshlrev_b32 v20, 16, v30
    v_and_b32 v21, 0xffff0000, v30
    v_lshlrev_b32 v22, 16, v31
    v_and_b32 v23, 0xffff0000, v31
    v_lshlrev_b32 v24, 16, v10
    v_and_b32 v25, 0xffff0000, v10
    v_lshlrev_b32 v26, 16, v11
    v_and_b32 v27, 0xffff0000, v11
    v_mul_f32 v24, s65, v24
    v_mul_f32 v25, s69, v25
    v_mul_f32 v26, s73, v26
    v_mul_f32 v27, s77, v27
    v_cvt_pk_bf16_f32 v30, v24, v25
    v_cvt_pk_bf16_f32 v31, v26, v27
    v_lshlrev_b32 v24, 16, v30
    v_and_b32 v25, 0xffff0000, v30
    v_lshlrev_b32 v26, 16, v31
    v_and_b32 v27, 0xffff0000, v31
    v_add_f32 v20, v20, v24
    v_add_f32 v21, v21, v25
    v_add_f32 v22, v22, v26
    v_add_f32 v23, v23, v27
    v_cvt_pk_bf16_f32 v30, v20, v21
    v_cvt_pk_bf16_f32 v31, v22, v23
    v_lshlrev_b32 v20, 16, v30
    v_and_b32 v21, 0xffff0000, v30
    v_lshlrev_b32 v22, 16, v31
    v_and_b32 v23, 0xffff0000, v31
    v_lshlrev_b32 v24, 16, v46
    v_and_b32 v25, 0xffff0000, v46
    v_lshlrev_b32 v26, 16, v47
    v_and_b32 v27, 0xffff0000, v47
    v_mul_f32 v24, s64, v24
    v_mul_f32 v25, s68, v25
    v_mul_f32 v26, s72, v26
    v_mul_f32 v27, s76, v27
    v_cvt_pk_bf16_f32 v30, v24, v25
    v_cvt_pk_bf16_f32 v31, v26, v27
    v_lshlrev_b32 v24, 16, v30
    v_and_b32 v25, 0xffff0000, v30
    v_lshlrev_b32 v26, 16, v31
    v_and_b32 v27, 0xffff0000, v31
    v_add_f32 v20, v20, v24
    v_add_f32 v21, v21, v25
    v_add_f32 v22, v22, v26
    v_add_f32 v23, v23, v27
    v_cvt_pk_bf16_f32 v30, v20, v21
    v_cvt_pk_bf16_f32 v31, v22, v23
    v_lshlrev_b32 v20, 16, v30
    v_and_b32 v21, 0xffff0000, v30
    v_lshlrev_b32 v22, 16, v31
    v_and_b32 v23, 0xffff0000, v31
    v_lshlrev_b32 v24, 16, v62
    v_and_b32 v25, 0xffff0000, v62
    v_lshlrev_b32 v26, 16, v63
    v_and_b32 v27, 0xffff0000, v63
    v_mul_f32 v20, v20, v24
    v_mul_f32 v21, v21, v25
    v_mul_f32 v22, v22, v26
    v_mul_f32 v23, v23, v27
    v_cvt_pk_bf16_f32 v46, v20, v21
    v_cvt_pk_bf16_f32 v47, v22, v23
    ds_write_b16 v1, v46 offset:712
    ds_write_b16 v1, v46 offset:5130
    ds_write_b16 v1, v46 offset:9548
    ds_write_b16 v1, v46 offset:13966
    ds_write_b16_d16_hi v1, v46 offset:25976
    ds_write_b16_d16_hi v1, v46 offset:30394
    ds_write_b16_d16_hi v1, v46 offset:34812
    ds_write_b16_d16_hi v1, v46 offset:39230
    ds_write_b16 v2, v47 offset:712
    ds_write_b16 v2, v47 offset:5130
    ds_write_b16 v2, v47 offset:9548
    ds_write_b16 v2, v47 offset:13966
    ds_write_b16_d16_hi v2, v47 offset:25976
    ds_write_b16_d16_hi v2, v47 offset:30394
    ds_write_b16_d16_hi v2, v47 offset:34812
    ds_write_b16_d16_hi v2, v47 offset:39230
    ds_read_b64 v[10:11], v18 offset:3088
    ds_read_b64 v[12:13], v18 offset:3080
    ds_read_b64 v[14:15], v18 offset:3072
    s_waitcnt lgkmcnt(0)
    v_lshlrev_b32 v24, 16, v14
    v_and_b32 v25, 0xffff0000, v14
    v_lshlrev_b32 v26, 16, v15
    v_and_b32 v27, 0xffff0000, v15
    v_mul_f32 v24, s67, v24
    v_mul_f32 v25, s71, v25
    v_mul_f32 v26, s75, v26
    v_mul_f32 v27, s79, v27
    v_cvt_pk_bf16_f32 v30, v24, v25
    v_cvt_pk_bf16_f32 v31, v26, v27
    v_lshlrev_b32 v24, 16, v30
    v_and_b32 v25, 0xffff0000, v30
    v_lshlrev_b32 v26, 16, v31
    v_and_b32 v27, 0xffff0000, v31
    v_mov_b32 v20, v24
    v_mov_b32 v21, v25
    v_mov_b32 v22, v26
    v_mov_b32 v23, v27
    v_lshlrev_b32 v24, 16, v12
    v_and_b32 v25, 0xffff0000, v12
    v_lshlrev_b32 v26, 16, v13
    v_and_b32 v27, 0xffff0000, v13
    v_mul_f32 v24, s66, v24
    v_mul_f32 v25, s70, v25
    v_mul_f32 v26, s74, v26
    v_mul_f32 v27, s78, v27
    v_cvt_pk_bf16_f32 v30, v24, v25
    v_cvt_pk_bf16_f32 v31, v26, v27
    v_lshlrev_b32 v24, 16, v30
    v_and_b32 v25, 0xffff0000, v30
    v_lshlrev_b32 v26, 16, v31
    v_and_b32 v27, 0xffff0000, v31
    v_add_f32 v20, v20, v24
    v_add_f32 v21, v21, v25
    v_add_f32 v22, v22, v26
    v_add_f32 v23, v23, v27
    v_cvt_pk_bf16_f32 v30, v20, v21
    v_cvt_pk_bf16_f32 v31, v22, v23
    v_lshlrev_b32 v20, 16, v30
    v_and_b32 v21, 0xffff0000, v30
    v_lshlrev_b32 v22, 16, v31
    v_and_b32 v23, 0xffff0000, v31
    v_lshlrev_b32 v24, 16, v10
    v_and_b32 v25, 0xffff0000, v10
    v_lshlrev_b32 v26, 16, v11
    v_and_b32 v27, 0xffff0000, v11
    v_mul_f32 v24, s65, v24
    v_mul_f32 v25, s69, v25
    v_mul_f32 v26, s73, v26
    v_mul_f32 v27, s77, v27
    v_cvt_pk_bf16_f32 v30, v24, v25
    v_cvt_pk_bf16_f32 v31, v26, v27
    v_lshlrev_b32 v24, 16, v30
    v_and_b32 v25, 0xffff0000, v30
    v_lshlrev_b32 v26, 16, v31
    v_and_b32 v27, 0xffff0000, v31
    v_add_f32 v20, v20, v24
    v_add_f32 v21, v21, v25
    v_add_f32 v22, v22, v26
    v_add_f32 v23, v23, v27
    v_cvt_pk_bf16_f32 v30, v20, v21
    v_cvt_pk_bf16_f32 v31, v22, v23
    v_lshlrev_b32 v20, 16, v30
    v_and_b32 v21, 0xffff0000, v30
    v_lshlrev_b32 v22, 16, v31
    v_and_b32 v23, 0xffff0000, v31
    v_lshlrev_b32 v24, 16, v48
    v_and_b32 v25, 0xffff0000, v48
    v_lshlrev_b32 v26, 16, v49
    v_and_b32 v27, 0xffff0000, v49
    v_mul_f32 v24, s64, v24
    v_mul_f32 v25, s68, v25
    v_mul_f32 v26, s72, v26
    v_mul_f32 v27, s76, v27
    v_cvt_pk_bf16_f32 v30, v24, v25
    v_cvt_pk_bf16_f32 v31, v26, v27
    v_lshlrev_b32 v24, 16, v30
    v_and_b32 v25, 0xffff0000, v30
    v_lshlrev_b32 v26, 16, v31
    v_and_b32 v27, 0xffff0000, v31
    v_add_f32 v20, v20, v24
    v_add_f32 v21, v21, v25
    v_add_f32 v22, v22, v26
    v_add_f32 v23, v23, v27
    v_cvt_pk_bf16_f32 v30, v20, v21
    v_cvt_pk_bf16_f32 v31, v22, v23
    v_lshlrev_b32 v20, 16, v30
    v_and_b32 v21, 0xffff0000, v30
    v_lshlrev_b32 v22, 16, v31
    v_and_b32 v23, 0xffff0000, v31
    v_lshlrev_b32 v24, 16, v64
    v_and_b32 v25, 0xffff0000, v64
    v_lshlrev_b32 v26, 16, v65
    v_and_b32 v27, 0xffff0000, v65
    v_mul_f32 v20, v20, v24
    v_mul_f32 v21, v21, v25
    v_mul_f32 v22, v22, v26
    v_mul_f32 v23, v23, v27
    v_cvt_pk_bf16_f32 v48, v20, v21
    v_cvt_pk_bf16_f32 v49, v22, v23
    ds_write_b16 v1, v48 offset:840
    ds_write_b16 v1, v48 offset:5258
    ds_write_b16 v1, v48 offset:9676
    ds_write_b16 v1, v48 offset:14094
    ds_write_b16_d16_hi v1, v48 offset:26104
    ds_write_b16_d16_hi v1, v48 offset:30522
    ds_write_b16_d16_hi v1, v48 offset:34940
    ds_write_b16_d16_hi v1, v48 offset:39358
    ds_write_b16 v2, v49 offset:840
    ds_write_b16 v2, v49 offset:5258
    ds_write_b16 v2, v49 offset:9676
    ds_write_b16 v2, v49 offset:14094
    ds_write_b16_d16_hi v2, v49 offset:26104
    ds_write_b16_d16_hi v2, v49 offset:30522
    ds_write_b16_d16_hi v2, v49 offset:34940
    ds_write_b16_d16_hi v2, v49 offset:39358
    ds_read_b64 v[10:11], v18 offset:3600
    ds_read_b64 v[12:13], v18 offset:3592
    ds_read_b64 v[14:15], v18 offset:3584
    s_waitcnt lgkmcnt(0)
    v_lshlrev_b32 v24, 16, v14
    v_and_b32 v25, 0xffff0000, v14
    v_lshlrev_b32 v26, 16, v15
    v_and_b32 v27, 0xffff0000, v15
    v_mul_f32 v24, s67, v24
    v_mul_f32 v25, s71, v25
    v_mul_f32 v26, s75, v26
    v_mul_f32 v27, s79, v27
    v_cvt_pk_bf16_f32 v30, v24, v25
    v_cvt_pk_bf16_f32 v31, v26, v27
    v_lshlrev_b32 v24, 16, v30
    v_and_b32 v25, 0xffff0000, v30
    v_lshlrev_b32 v26, 16, v31
    v_and_b32 v27, 0xffff0000, v31
    v_mov_b32 v20, v24
    v_mov_b32 v21, v25
    v_mov_b32 v22, v26
    v_mov_b32 v23, v27
    v_lshlrev_b32 v24, 16, v12
    v_and_b32 v25, 0xffff0000, v12
    v_lshlrev_b32 v26, 16, v13
    v_and_b32 v27, 0xffff0000, v13
    v_mul_f32 v24, s66, v24
    v_mul_f32 v25, s70, v25
    v_mul_f32 v26, s74, v26
    v_mul_f32 v27, s78, v27
    v_cvt_pk_bf16_f32 v30, v24, v25
    v_cvt_pk_bf16_f32 v31, v26, v27
    v_lshlrev_b32 v24, 16, v30
    v_and_b32 v25, 0xffff0000, v30
    v_lshlrev_b32 v26, 16, v31
    v_and_b32 v27, 0xffff0000, v31
    v_add_f32 v20, v20, v24
    v_add_f32 v21, v21, v25
    v_add_f32 v22, v22, v26
    v_add_f32 v23, v23, v27
    v_cvt_pk_bf16_f32 v30, v20, v21
    v_cvt_pk_bf16_f32 v31, v22, v23
    v_lshlrev_b32 v20, 16, v30
    v_and_b32 v21, 0xffff0000, v30
    v_lshlrev_b32 v22, 16, v31
    v_and_b32 v23, 0xffff0000, v31
    v_lshlrev_b32 v24, 16, v10
    v_and_b32 v25, 0xffff0000, v10
    v_lshlrev_b32 v26, 16, v11
    v_and_b32 v27, 0xffff0000, v11
    v_mul_f32 v24, s65, v24
    v_mul_f32 v25, s69, v25
    v_mul_f32 v26, s73, v26
    v_mul_f32 v27, s77, v27
    v_cvt_pk_bf16_f32 v30, v24, v25
    v_cvt_pk_bf16_f32 v31, v26, v27
    v_lshlrev_b32 v24, 16, v30
    v_and_b32 v25, 0xffff0000, v30
    v_lshlrev_b32 v26, 16, v31
    v_and_b32 v27, 0xffff0000, v31
    v_add_f32 v20, v20, v24
    v_add_f32 v21, v21, v25
    v_add_f32 v22, v22, v26
    v_add_f32 v23, v23, v27
    v_cvt_pk_bf16_f32 v30, v20, v21
    v_cvt_pk_bf16_f32 v31, v22, v23
    v_lshlrev_b32 v20, 16, v30
    v_and_b32 v21, 0xffff0000, v30
    v_lshlrev_b32 v22, 16, v31
    v_and_b32 v23, 0xffff0000, v31
    v_lshlrev_b32 v24, 16, v50
    v_and_b32 v25, 0xffff0000, v50
    v_lshlrev_b32 v26, 16, v51
    v_and_b32 v27, 0xffff0000, v51
    v_mul_f32 v24, s64, v24
    v_mul_f32 v25, s68, v25
    v_mul_f32 v26, s72, v26
    v_mul_f32 v27, s76, v27
    v_cvt_pk_bf16_f32 v30, v24, v25
    v_cvt_pk_bf16_f32 v31, v26, v27
    v_lshlrev_b32 v24, 16, v30
    v_and_b32 v25, 0xffff0000, v30
    v_lshlrev_b32 v26, 16, v31
    v_and_b32 v27, 0xffff0000, v31
    v_add_f32 v20, v20, v24
    v_add_f32 v21, v21, v25
    v_add_f32 v22, v22, v26
    v_add_f32 v23, v23, v27
    v_cvt_pk_bf16_f32 v30, v20, v21
    v_cvt_pk_bf16_f32 v31, v22, v23
    v_lshlrev_b32 v20, 16, v30
    v_and_b32 v21, 0xffff0000, v30
    v_lshlrev_b32 v22, 16, v31
    v_and_b32 v23, 0xffff0000, v31
    v_lshlrev_b32 v24, 16, v66
    v_and_b32 v25, 0xffff0000, v66
    v_lshlrev_b32 v26, 16, v67
    v_and_b32 v27, 0xffff0000, v67
    v_mul_f32 v20, v20, v24
    v_mul_f32 v21, v21, v25
    v_mul_f32 v22, v22, v26
    v_mul_f32 v23, v23, v27
    v_cvt_pk_bf16_f32 v50, v20, v21
    v_cvt_pk_bf16_f32 v51, v22, v23
    ds_write_b16 v1, v50 offset:968
    ds_write_b16 v1, v50 offset:5386
    ds_write_b16 v1, v50 offset:9804
    ds_write_b16 v1, v50 offset:14222
    ds_write_b16_d16_hi v1, v50 offset:26232
    ds_write_b16_d16_hi v1, v50 offset:30650
    ds_write_b16_d16_hi v1, v50 offset:35068
    ds_write_b16_d16_hi v1, v50 offset:39486
    ds_write_b16 v2, v51 offset:968
    ds_write_b16 v2, v51 offset:5386
    ds_write_b16 v2, v51 offset:9804
    ds_write_b16 v2, v51 offset:14222
    ds_write_b16_d16_hi v2, v51 offset:26232
    ds_write_b16_d16_hi v2, v51 offset:30650
    ds_write_b16_d16_hi v2, v51 offset:35068
    ds_write_b16_d16_hi v2, v51 offset:39486
    s_mov_b32 s8, s46
    s_and_b32 s9, s47, 0xffff
    s_mov_b32 s10, 0x200000
    s_mov_b32 s11, 0x00020000
    s_mov_b32 s7, 0
    buffer_load_dwordx2 v[52:53], v8, s[8:11], s7 offen
    s_mov_b32 s7, 65536
    buffer_load_dwordx2 v[54:55], v8, s[8:11], s7 offen
    s_mov_b32 s7, 131072
    buffer_load_dwordx2 v[56:57], v8, s[8:11], s7 offen
    s_mov_b32 s7, 196608
    buffer_load_dwordx2 v[58:59], v8, s[8:11], s7 offen
    s_mov_b32 s7, 262144
    buffer_load_dwordx2 v[60:61], v8, s[8:11], s7 offen
    s_mov_b32 s7, 327680
    buffer_load_dwordx2 v[62:63], v8, s[8:11], s7 offen
    s_mov_b32 s7, 393216
    buffer_load_dwordx2 v[64:65], v8, s[8:11], s7 offen
    s_mov_b32 s7, 458752
    buffer_load_dwordx2 v[66:67], v8, s[8:11], s7 offen
    s_waitcnt lgkmcnt(0)
    s_barrier
    v_mov_b32 v68, 0
    v_mov_b32 v69, 0
    v_mov_b32 v70, 0
    v_mov_b32 v71, 0
    v_mov_b32 v72, 0
    v_mov_b32 v73, 0
    v_mov_b32 v74, 0
    v_mov_b32 v75, 0
    v_mov_b32 v76, 0
    v_mov_b32 v77, 0
    v_mov_b32 v78, 0
    v_mov_b32 v79, 0
    v_mov_b32 v80, 0
    v_mov_b32 v81, 0
    v_mov_b32 v82, 0
    v_mov_b32 v83, 0
    v_mov_b32 v84, 0
    v_mov_b32 v85, 0
    v_mov_b32 v86, 0
    v_mov_b32 v87, 0
    v_mov_b32 v88, 0
    v_mov_b32 v89, 0
    v_mov_b32 v90, 0
    v_mov_b32 v91, 0
    v_mov_b32 v92, 0
    v_mov_b32 v93, 0
    v_mov_b32 v94, 0
    v_mov_b32 v95, 0
    v_mov_b32 v96, 0
    v_mov_b32 v97, 0
    v_mov_b32 v98, 0
    v_mov_b32 v99, 0
    ds_read_b64 v[100:101], v3 offset:32
    ds_read_b64 v[102:103], v3 offset:40
    ds_read_b128 v[104:107], v4 offset:5040
    ds_read_b128 v[108:111], v4 offset:2480
    ds_read_b64 v[112:113], v3 offset:0
    ds_read_b64 v[114:115], v3 offset:8
    ds_read_b128 v[116:119], v4 offset:5072
    ds_read_b128 v[120:123], v4 offset:2512
    ds_read_b64 v[124:125], v3 offset:96
    ds_read_b64 v[126:127], v3 offset:104
    ds_read_b128 v[128:131], v4 offset:4960
    ds_read_b128 v[132:135], v4 offset:2400
    s_waitcnt lgkmcnt(8)
    v_mfma_f32_32x32x16_bf16 v[84:99], v[100:103], v[104:107], v[84:99]
    v_mfma_f32_32x32x16_bf16 v[68:83], v[100:103], v[108:111], v[68:83]
    ds_read_b64 v[100:101], v3 offset:64
    ds_read_b64 v[102:103], v3 offset:72
    ds_read_b128 v[104:107], v4 offset:4992
    ds_read_b128 v[108:111], v4 offset:2432
    s_waitcnt lgkmcnt(8)
    v_mfma_f32_32x32x16_bf16 v[84:99], v[112:115], v[116:119], v[84:99]
    v_mfma_f32_32x32x16_bf16 v[68:83], v[112:115], v[120:123], v[68:83]
    ds_read_b64 v[112:113], v3 offset:160
    ds_read_b64 v[114:115], v3 offset:168
    ds_read_b128 v[116:119], v4 offset:4880
    ds_read_b128 v[120:123], v4 offset:2320
    s_waitcnt lgkmcnt(8)
    v_mfma_f32_32x32x16_bf16 v[84:99], v[124:127], v[128:131], v[84:99]
    v_mfma_f32_32x32x16_bf16 v[68:83], v[124:127], v[132:135], v[68:83]
    ds_read_b64 v[124:125], v3 offset:128
    ds_read_b64 v[126:127], v3 offset:136
    ds_read_b128 v[128:131], v4 offset:4912
    ds_read_b128 v[132:135], v4 offset:2352
    s_waitcnt lgkmcnt(8)
    v_mfma_f32_32x32x16_bf16 v[84:99], v[100:103], v[104:107], v[84:99]
    v_mfma_f32_32x32x16_bf16 v[68:83], v[100:103], v[108:111], v[68:83]
    ds_read_b64 v[100:101], v3 offset:224
    ds_read_b64 v[102:103], v3 offset:232
    ds_read_b128 v[104:107], v4 offset:4800
    ds_read_b128 v[108:111], v4 offset:2240
    s_waitcnt lgkmcnt(8)
    v_mfma_f32_32x32x16_bf16 v[84:99], v[112:115], v[116:119], v[84:99]
    v_mfma_f32_32x32x16_bf16 v[68:83], v[112:115], v[120:123], v[68:83]
    ds_read_b64 v[112:113], v3 offset:192
    ds_read_b64 v[114:115], v3 offset:200
    ds_read_b128 v[116:119], v4 offset:4832
    ds_read_b128 v[120:123], v4 offset:2272
    s_waitcnt lgkmcnt(8)
    v_mfma_f32_32x32x16_bf16 v[84:99], v[124:127], v[128:131], v[84:99]
    v_mfma_f32_32x32x16_bf16 v[68:83], v[124:127], v[132:135], v[68:83]
    ds_read_b64 v[124:125], v3 offset:288
    ds_read_b64 v[126:127], v3 offset:296
    ds_read_b128 v[128:131], v4 offset:4720
    ds_read_b128 v[132:135], v4 offset:2160
    s_waitcnt lgkmcnt(8)
    v_mfma_f32_32x32x16_bf16 v[84:99], v[100:103], v[104:107], v[84:99]
    v_mfma_f32_32x32x16_bf16 v[68:83], v[100:103], v[108:111], v[68:83]
    ds_read_b64 v[100:101], v3 offset:256
    ds_read_b64 v[102:103], v3 offset:264
    ds_read_b128 v[104:107], v4 offset:4752
    ds_read_b128 v[108:111], v4 offset:2192
    s_waitcnt lgkmcnt(8)
    v_mfma_f32_32x32x16_bf16 v[84:99], v[112:115], v[116:119], v[84:99]
    v_mfma_f32_32x32x16_bf16 v[68:83], v[112:115], v[120:123], v[68:83]
    ds_read_b64 v[112:113], v3 offset:352
    ds_read_b64 v[114:115], v3 offset:360
    ds_read_b128 v[116:119], v4 offset:4640
    ds_read_b128 v[120:123], v4 offset:2080
    s_waitcnt lgkmcnt(8)
    v_mfma_f32_32x32x16_bf16 v[84:99], v[124:127], v[128:131], v[84:99]
    v_mfma_f32_32x32x16_bf16 v[68:83], v[124:127], v[132:135], v[68:83]
    ds_read_b64 v[124:125], v3 offset:320
    ds_read_b64 v[126:127], v3 offset:328
    ds_read_b128 v[128:131], v4 offset:4672
    ds_read_b128 v[132:135], v4 offset:2112
    s_waitcnt lgkmcnt(8)
    v_mfma_f32_32x32x16_bf16 v[84:99], v[100:103], v[104:107], v[84:99]
    v_mfma_f32_32x32x16_bf16 v[68:83], v[100:103], v[108:111], v[68:83]
    ds_read_b64 v[100:101], v3 offset:416
    ds_read_b64 v[102:103], v3 offset:424
    ds_read_b128 v[104:107], v4 offset:4560
    ds_read_b128 v[108:111], v4 offset:2000
    s_waitcnt lgkmcnt(8)
    v_mfma_f32_32x32x16_bf16 v[84:99], v[112:115], v[116:119], v[84:99]
    v_mfma_f32_32x32x16_bf16 v[68:83], v[112:115], v[120:123], v[68:83]
    ds_read_b64 v[112:113], v3 offset:384
    ds_read_b64 v[114:115], v3 offset:392
    ds_read_b128 v[116:119], v4 offset:4592
    ds_read_b128 v[120:123], v4 offset:2032
    s_waitcnt lgkmcnt(8)
    v_mfma_f32_32x32x16_bf16 v[84:99], v[124:127], v[128:131], v[84:99]
    v_mfma_f32_32x32x16_bf16 v[68:83], v[124:127], v[132:135], v[68:83]
    ds_read_b64 v[124:125], v3 offset:480
    ds_read_b64 v[126:127], v3 offset:488
    ds_read_b128 v[128:131], v4 offset:4480
    ds_read_b128 v[132:135], v4 offset:1920
    s_waitcnt lgkmcnt(8)
    v_mfma_f32_32x32x16_bf16 v[84:99], v[100:103], v[104:107], v[84:99]
    v_mfma_f32_32x32x16_bf16 v[68:83], v[100:103], v[108:111], v[68:83]
    ds_read_b64 v[100:101], v3 offset:448
    ds_read_b64 v[102:103], v3 offset:456
    ds_read_b128 v[104:107], v4 offset:4512
    ds_read_b128 v[108:111], v4 offset:1952
    s_waitcnt lgkmcnt(8)
    v_mfma_f32_32x32x16_bf16 v[84:99], v[112:115], v[116:119], v[84:99]
    v_mfma_f32_32x32x16_bf16 v[68:83], v[112:115], v[120:123], v[68:83]
    ds_read_b64 v[112:113], v3 offset:544
    ds_read_b64 v[114:115], v3 offset:552
    ds_read_b128 v[116:119], v4 offset:4400
    ds_read_b128 v[120:123], v4 offset:1840
    s_waitcnt lgkmcnt(8)
    v_mfma_f32_32x32x16_bf16 v[84:99], v[124:127], v[128:131], v[84:99]
    v_mfma_f32_32x32x16_bf16 v[68:83], v[124:127], v[132:135], v[68:83]
    ds_read_b64 v[124:125], v3 offset:512
    ds_read_b64 v[126:127], v3 offset:520
    ds_read_b128 v[128:131], v4 offset:4432
    ds_read_b128 v[132:135], v4 offset:1872
    s_waitcnt lgkmcnt(8)
    v_mfma_f32_32x32x16_bf16 v[84:99], v[100:103], v[104:107], v[84:99]
    v_mfma_f32_32x32x16_bf16 v[68:83], v[100:103], v[108:111], v[68:83]
    ds_read_b64 v[100:101], v3 offset:608
    ds_read_b64 v[102:103], v3 offset:616
    ds_read_b128 v[104:107], v4 offset:4320
    ds_read_b128 v[108:111], v4 offset:1760
    s_waitcnt lgkmcnt(8)
    v_mfma_f32_32x32x16_bf16 v[84:99], v[112:115], v[116:119], v[84:99]
    v_mfma_f32_32x32x16_bf16 v[68:83], v[112:115], v[120:123], v[68:83]
    ds_read_b64 v[112:113], v3 offset:576
    ds_read_b64 v[114:115], v3 offset:584
    ds_read_b128 v[116:119], v4 offset:4352
    ds_read_b128 v[120:123], v4 offset:1792
    s_waitcnt lgkmcnt(8)
    v_mfma_f32_32x32x16_bf16 v[84:99], v[124:127], v[128:131], v[84:99]
    v_mfma_f32_32x32x16_bf16 v[68:83], v[124:127], v[132:135], v[68:83]
    ds_read_b64 v[124:125], v3 offset:672
    ds_read_b64 v[126:127], v3 offset:680
    ds_read_b128 v[128:131], v4 offset:4240
    ds_read_b128 v[132:135], v4 offset:1680
    s_waitcnt lgkmcnt(8)
    v_mfma_f32_32x32x16_bf16 v[84:99], v[100:103], v[104:107], v[84:99]
    v_mfma_f32_32x32x16_bf16 v[68:83], v[100:103], v[108:111], v[68:83]
    ds_read_b64 v[100:101], v3 offset:640
    ds_read_b64 v[102:103], v3 offset:648
    ds_read_b128 v[104:107], v4 offset:4272
    ds_read_b128 v[108:111], v4 offset:1712
    s_waitcnt lgkmcnt(8)
    v_mfma_f32_32x32x16_bf16 v[84:99], v[112:115], v[116:119], v[84:99]
    v_mfma_f32_32x32x16_bf16 v[68:83], v[112:115], v[120:123], v[68:83]
    ds_read_b64 v[112:113], v3 offset:736
    ds_read_b64 v[114:115], v3 offset:744
    ds_read_b128 v[116:119], v4 offset:4160
    ds_read_b128 v[120:123], v4 offset:1600
    s_waitcnt lgkmcnt(8)
    v_mfma_f32_32x32x16_bf16 v[84:99], v[124:127], v[128:131], v[84:99]
    v_mfma_f32_32x32x16_bf16 v[68:83], v[124:127], v[132:135], v[68:83]
    ds_read_b64 v[124:125], v3 offset:704
    ds_read_b64 v[126:127], v3 offset:712
    ds_read_b128 v[128:131], v4 offset:4192
    ds_read_b128 v[132:135], v4 offset:1632
    s_waitcnt lgkmcnt(8)
    v_mfma_f32_32x32x16_bf16 v[84:99], v[100:103], v[104:107], v[84:99]
    v_mfma_f32_32x32x16_bf16 v[68:83], v[100:103], v[108:111], v[68:83]
    ds_read_b64 v[100:101], v3 offset:800
    ds_read_b64 v[102:103], v3 offset:808
    ds_read_b128 v[104:107], v4 offset:4080
    ds_read_b128 v[108:111], v4 offset:1520
    s_waitcnt lgkmcnt(8)
    v_mfma_f32_32x32x16_bf16 v[84:99], v[112:115], v[116:119], v[84:99]
    v_mfma_f32_32x32x16_bf16 v[68:83], v[112:115], v[120:123], v[68:83]
    ds_read_b64 v[112:113], v3 offset:768
    ds_read_b64 v[114:115], v3 offset:776
    ds_read_b128 v[116:119], v4 offset:4112
    ds_read_b128 v[120:123], v4 offset:1552
    s_waitcnt lgkmcnt(8)
    v_mfma_f32_32x32x16_bf16 v[84:99], v[124:127], v[128:131], v[84:99]
    v_mfma_f32_32x32x16_bf16 v[68:83], v[124:127], v[132:135], v[68:83]
    ds_read_b64 v[124:125], v3 offset:864
    ds_read_b64 v[126:127], v3 offset:872
    ds_read_b128 v[128:131], v4 offset:4000
    ds_read_b128 v[132:135], v4 offset:1440
    s_waitcnt lgkmcnt(8)
    v_mfma_f32_32x32x16_bf16 v[84:99], v[100:103], v[104:107], v[84:99]
    v_mfma_f32_32x32x16_bf16 v[68:83], v[100:103], v[108:111], v[68:83]
    ds_read_b64 v[100:101], v3 offset:832
    ds_read_b64 v[102:103], v3 offset:840
    ds_read_b128 v[104:107], v4 offset:4032
    ds_read_b128 v[108:111], v4 offset:1472
    s_waitcnt lgkmcnt(8)
    v_mfma_f32_32x32x16_bf16 v[84:99], v[112:115], v[116:119], v[84:99]
    v_mfma_f32_32x32x16_bf16 v[68:83], v[112:115], v[120:123], v[68:83]
    ds_read_b64 v[112:113], v3 offset:928
    ds_read_b64 v[114:115], v3 offset:936
    ds_read_b128 v[116:119], v4 offset:3920
    ds_read_b128 v[120:123], v4 offset:1360
    s_waitcnt lgkmcnt(8)
    v_mfma_f32_32x32x16_bf16 v[84:99], v[124:127], v[128:131], v[84:99]
    v_mfma_f32_32x32x16_bf16 v[68:83], v[124:127], v[132:135], v[68:83]
    ds_read_b64 v[124:125], v3 offset:896
    ds_read_b64 v[126:127], v3 offset:904
    ds_read_b128 v[128:131], v4 offset:3952
    ds_read_b128 v[132:135], v4 offset:1392
    s_waitcnt lgkmcnt(8)
    v_mfma_f32_32x32x16_bf16 v[84:99], v[100:103], v[104:107], v[84:99]
    v_mfma_f32_32x32x16_bf16 v[68:83], v[100:103], v[108:111], v[68:83]
    ds_read_b64 v[100:101], v3 offset:992
    ds_read_b64 v[102:103], v3 offset:1000
    ds_read_b128 v[104:107], v4 offset:3840
    ds_read_b128 v[108:111], v4 offset:1280
    s_waitcnt lgkmcnt(8)
    v_mfma_f32_32x32x16_bf16 v[84:99], v[112:115], v[116:119], v[84:99]
    v_mfma_f32_32x32x16_bf16 v[68:83], v[112:115], v[120:123], v[68:83]
    ds_read_b64 v[112:113], v3 offset:960
    ds_read_b64 v[114:115], v3 offset:968
    ds_read_b128 v[116:119], v4 offset:3872
    ds_read_b128 v[120:123], v4 offset:1312
    s_waitcnt lgkmcnt(8)
    v_mfma_f32_32x32x16_bf16 v[84:99], v[124:127], v[128:131], v[84:99]
    v_mfma_f32_32x32x16_bf16 v[68:83], v[124:127], v[132:135], v[68:83]
    ds_read_b64 v[124:125], v3 offset:1056
    ds_read_b64 v[126:127], v3 offset:1064
    ds_read_b128 v[128:131], v4 offset:3760
    ds_read_b128 v[132:135], v4 offset:1200
    s_waitcnt lgkmcnt(8)
    v_mfma_f32_32x32x16_bf16 v[84:99], v[100:103], v[104:107], v[84:99]
    v_mfma_f32_32x32x16_bf16 v[68:83], v[100:103], v[108:111], v[68:83]
    ds_read_b64 v[100:101], v3 offset:1024
    ds_read_b64 v[102:103], v3 offset:1032
    ds_read_b128 v[104:107], v4 offset:3792
    ds_read_b128 v[108:111], v4 offset:1232
    s_waitcnt lgkmcnt(8)
    v_mfma_f32_32x32x16_bf16 v[84:99], v[112:115], v[116:119], v[84:99]
    v_mfma_f32_32x32x16_bf16 v[68:83], v[112:115], v[120:123], v[68:83]
    ds_read_b64 v[112:113], v3 offset:1120
    ds_read_b64 v[114:115], v3 offset:1128
    ds_read_b128 v[116:119], v4 offset:3680
    ds_read_b128 v[120:123], v4 offset:1120
    s_waitcnt lgkmcnt(8)
    v_mfma_f32_32x32x16_bf16 v[84:99], v[124:127], v[128:131], v[84:99]
    v_mfma_f32_32x32x16_bf16 v[68:83], v[124:127], v[132:135], v[68:83]
    ds_read_b64 v[124:125], v3 offset:1088
    ds_read_b64 v[126:127], v3 offset:1096
    ds_read_b128 v[128:131], v4 offset:3712
    ds_read_b128 v[132:135], v4 offset:1152
    s_waitcnt lgkmcnt(8)
    v_mfma_f32_32x32x16_bf16 v[84:99], v[100:103], v[104:107], v[84:99]
    v_mfma_f32_32x32x16_bf16 v[68:83], v[100:103], v[108:111], v[68:83]
    ds_read_b64 v[100:101], v3 offset:1184
    ds_read_b64 v[102:103], v3 offset:1192
    ds_read_b128 v[104:107], v4 offset:3600
    ds_read_b128 v[108:111], v4 offset:1040
    s_waitcnt lgkmcnt(8)
    v_mfma_f32_32x32x16_bf16 v[84:99], v[112:115], v[116:119], v[84:99]
    v_mfma_f32_32x32x16_bf16 v[68:83], v[112:115], v[120:123], v[68:83]
    ds_read_b64 v[112:113], v3 offset:1152
    ds_read_b64 v[114:115], v3 offset:1160
    ds_read_b128 v[116:119], v4 offset:3632
    ds_read_b128 v[120:123], v4 offset:1072
    s_waitcnt lgkmcnt(8)
    v_mfma_f32_32x32x16_bf16 v[84:99], v[124:127], v[128:131], v[84:99]
    v_mfma_f32_32x32x16_bf16 v[68:83], v[124:127], v[132:135], v[68:83]
    ds_read_b64 v[124:125], v3 offset:1248
    ds_read_b64 v[126:127], v3 offset:1256
    ds_read_b128 v[128:131], v4 offset:3520
    ds_read_b128 v[132:135], v4 offset:960
    s_waitcnt lgkmcnt(8)
    v_mfma_f32_32x32x16_bf16 v[84:99], v[100:103], v[104:107], v[84:99]
    v_mfma_f32_32x32x16_bf16 v[68:83], v[100:103], v[108:111], v[68:83]
    ds_read_b64 v[100:101], v3 offset:1216
    ds_read_b64 v[102:103], v3 offset:1224
    ds_read_b128 v[104:107], v4 offset:3552
    ds_read_b128 v[108:111], v4 offset:992
    s_waitcnt lgkmcnt(8)
    v_mfma_f32_32x32x16_bf16 v[84:99], v[112:115], v[116:119], v[84:99]
    v_mfma_f32_32x32x16_bf16 v[68:83], v[112:115], v[120:123], v[68:83]
    ds_read_b64 v[112:113], v3 offset:1312
    ds_read_b64 v[114:115], v3 offset:1320
    ds_read_b128 v[116:119], v4 offset:3440
    ds_read_b128 v[120:123], v4 offset:880
    s_waitcnt lgkmcnt(8)
    v_mfma_f32_32x32x16_bf16 v[84:99], v[124:127], v[128:131], v[84:99]
    v_mfma_f32_32x32x16_bf16 v[68:83], v[124:127], v[132:135], v[68:83]
    ds_read_b64 v[124:125], v3 offset:1280
    ds_read_b64 v[126:127], v3 offset:1288
    ds_read_b128 v[128:131], v4 offset:3472
    ds_read_b128 v[132:135], v4 offset:912
    s_waitcnt lgkmcnt(8)
    v_mfma_f32_32x32x16_bf16 v[84:99], v[100:103], v[104:107], v[84:99]
    v_mfma_f32_32x32x16_bf16 v[68:83], v[100:103], v[108:111], v[68:83]
    ds_read_b64 v[100:101], v3 offset:1376
    ds_read_b64 v[102:103], v3 offset:1384
    ds_read_b128 v[104:107], v4 offset:3360
    ds_read_b128 v[108:111], v4 offset:800
    s_waitcnt lgkmcnt(8)
    v_mfma_f32_32x32x16_bf16 v[84:99], v[112:115], v[116:119], v[84:99]
    v_mfma_f32_32x32x16_bf16 v[68:83], v[112:115], v[120:123], v[68:83]
    ds_read_b64 v[112:113], v3 offset:1344
    ds_read_b64 v[114:115], v3 offset:1352
    ds_read_b128 v[116:119], v4 offset:3392
    ds_read_b128 v[120:123], v4 offset:832
    s_waitcnt lgkmcnt(8)
    v_mfma_f32_32x32x16_bf16 v[84:99], v[124:127], v[128:131], v[84:99]
    v_mfma_f32_32x32x16_bf16 v[68:83], v[124:127], v[132:135], v[68:83]
    ds_read_b64 v[124:125], v3 offset:1440
    ds_read_b64 v[126:127], v3 offset:1448
    ds_read_b128 v[128:131], v4 offset:3280
    ds_read_b128 v[132:135], v4 offset:720
    s_waitcnt lgkmcnt(8)
    v_mfma_f32_32x32x16_bf16 v[84:99], v[100:103], v[104:107], v[84:99]
    v_mfma_f32_32x32x16_bf16 v[68:83], v[100:103], v[108:111], v[68:83]
    ds_read_b64 v[100:101], v3 offset:1408
    ds_read_b64 v[102:103], v3 offset:1416
    ds_read_b128 v[104:107], v4 offset:3312
    ds_read_b128 v[108:111], v4 offset:752
    s_waitcnt lgkmcnt(8)
    v_mfma_f32_32x32x16_bf16 v[84:99], v[112:115], v[116:119], v[84:99]
    v_mfma_f32_32x32x16_bf16 v[68:83], v[112:115], v[120:123], v[68:83]
    ds_read_b64 v[112:113], v3 offset:1504
    ds_read_b64 v[114:115], v3 offset:1512
    ds_read_b128 v[116:119], v4 offset:3200
    ds_read_b128 v[120:123], v4 offset:640
    s_waitcnt lgkmcnt(8)
    v_mfma_f32_32x32x16_bf16 v[84:99], v[124:127], v[128:131], v[84:99]
    v_mfma_f32_32x32x16_bf16 v[68:83], v[124:127], v[132:135], v[68:83]
    ds_read_b64 v[124:125], v3 offset:1472
    ds_read_b64 v[126:127], v3 offset:1480
    ds_read_b128 v[128:131], v4 offset:3232
    ds_read_b128 v[132:135], v4 offset:672
    s_waitcnt lgkmcnt(8)
    v_mfma_f32_32x32x16_bf16 v[84:99], v[100:103], v[104:107], v[84:99]
    v_mfma_f32_32x32x16_bf16 v[68:83], v[100:103], v[108:111], v[68:83]
    ds_read_b64 v[100:101], v3 offset:1568
    ds_read_b64 v[102:103], v3 offset:1576
    ds_read_b128 v[104:107], v4 offset:3120
    ds_read_b128 v[108:111], v4 offset:560
    s_waitcnt lgkmcnt(8)
    v_mfma_f32_32x32x16_bf16 v[84:99], v[112:115], v[116:119], v[84:99]
    v_mfma_f32_32x32x16_bf16 v[68:83], v[112:115], v[120:123], v[68:83]
    ds_read_b64 v[112:113], v3 offset:1536
    ds_read_b64 v[114:115], v3 offset:1544
    ds_read_b128 v[116:119], v4 offset:3152
    ds_read_b128 v[120:123], v4 offset:592
    s_waitcnt lgkmcnt(8)
    v_mfma_f32_32x32x16_bf16 v[84:99], v[124:127], v[128:131], v[84:99]
    v_mfma_f32_32x32x16_bf16 v[68:83], v[124:127], v[132:135], v[68:83]
    ds_read_b64 v[124:125], v3 offset:1632
    ds_read_b64 v[126:127], v3 offset:1640
    ds_read_b128 v[128:131], v4 offset:3040
    ds_read_b128 v[132:135], v4 offset:480
    s_waitcnt lgkmcnt(8)
    v_mfma_f32_32x32x16_bf16 v[84:99], v[100:103], v[104:107], v[84:99]
    v_mfma_f32_32x32x16_bf16 v[68:83], v[100:103], v[108:111], v[68:83]
    ds_read_b64 v[100:101], v3 offset:1600
    ds_read_b64 v[102:103], v3 offset:1608
    ds_read_b128 v[104:107], v4 offset:3072
    ds_read_b128 v[108:111], v4 offset:512
    s_waitcnt lgkmcnt(8)
    v_mfma_f32_32x32x16_bf16 v[84:99], v[112:115], v[116:119], v[84:99]
    v_mfma_f32_32x32x16_bf16 v[68:83], v[112:115], v[120:123], v[68:83]
    ds_read_b64 v[112:113], v3 offset:1696
    ds_read_b64 v[114:115], v3 offset:1704
    ds_read_b128 v[116:119], v4 offset:2960
    ds_read_b128 v[120:123], v4 offset:400
    s_waitcnt lgkmcnt(8)
    v_mfma_f32_32x32x16_bf16 v[84:99], v[124:127], v[128:131], v[84:99]
    v_mfma_f32_32x32x16_bf16 v[68:83], v[124:127], v[132:135], v[68:83]
    ds_read_b64 v[124:125], v3 offset:1664
    ds_read_b64 v[126:127], v3 offset:1672
    ds_read_b128 v[128:131], v4 offset:2992
    ds_read_b128 v[132:135], v4 offset:432
    s_waitcnt lgkmcnt(8)
    v_mfma_f32_32x32x16_bf16 v[84:99], v[100:103], v[104:107], v[84:99]
    v_mfma_f32_32x32x16_bf16 v[68:83], v[100:103], v[108:111], v[68:83]
    ds_read_b64 v[100:101], v3 offset:1760
    ds_read_b64 v[102:103], v3 offset:1768
    ds_read_b128 v[104:107], v4 offset:2880
    ds_read_b128 v[108:111], v4 offset:320
    s_waitcnt lgkmcnt(8)
    v_mfma_f32_32x32x16_bf16 v[84:99], v[112:115], v[116:119], v[84:99]
    v_mfma_f32_32x32x16_bf16 v[68:83], v[112:115], v[120:123], v[68:83]
    ds_read_b64 v[112:113], v3 offset:1728
    ds_read_b64 v[114:115], v3 offset:1736
    ds_read_b128 v[116:119], v4 offset:2912
    ds_read_b128 v[120:123], v4 offset:352
    s_waitcnt lgkmcnt(8)
    v_mfma_f32_32x32x16_bf16 v[84:99], v[124:127], v[128:131], v[84:99]
    v_mfma_f32_32x32x16_bf16 v[68:83], v[124:127], v[132:135], v[68:83]
    ds_read_b64 v[124:125], v3 offset:1824
    ds_read_b64 v[126:127], v3 offset:1832
    ds_read_b128 v[128:131], v4 offset:2800
    ds_read_b128 v[132:135], v4 offset:240
    s_waitcnt lgkmcnt(8)
    v_mfma_f32_32x32x16_bf16 v[84:99], v[100:103], v[104:107], v[84:99]
    v_mfma_f32_32x32x16_bf16 v[68:83], v[100:103], v[108:111], v[68:83]
    ds_read_b64 v[100:101], v3 offset:1792
    ds_read_b64 v[102:103], v3 offset:1800
    ds_read_b128 v[104:107], v4 offset:2832
    ds_read_b128 v[108:111], v4 offset:272
    s_waitcnt lgkmcnt(8)
    v_mfma_f32_32x32x16_bf16 v[84:99], v[112:115], v[116:119], v[84:99]
    v_mfma_f32_32x32x16_bf16 v[68:83], v[112:115], v[120:123], v[68:83]
    ds_read_b64 v[112:113], v3 offset:1888
    ds_read_b64 v[114:115], v3 offset:1896
    ds_read_b128 v[116:119], v4 offset:2720
    ds_read_b128 v[120:123], v4 offset:160
    s_waitcnt lgkmcnt(8)
    v_mfma_f32_32x32x16_bf16 v[84:99], v[124:127], v[128:131], v[84:99]
    v_mfma_f32_32x32x16_bf16 v[68:83], v[124:127], v[132:135], v[68:83]
    ds_read_b64 v[124:125], v3 offset:1856
    ds_read_b64 v[126:127], v3 offset:1864
    ds_read_b128 v[128:131], v4 offset:2752
    ds_read_b128 v[132:135], v4 offset:192
    s_waitcnt lgkmcnt(8)
    v_mfma_f32_32x32x16_bf16 v[84:99], v[100:103], v[104:107], v[84:99]
    v_mfma_f32_32x32x16_bf16 v[68:83], v[100:103], v[108:111], v[68:83]
    ds_read_b64 v[100:101], v3 offset:1952
    ds_read_b64 v[102:103], v3 offset:1960
    ds_read_b128 v[104:107], v4 offset:2640
    ds_read_b128 v[108:111], v4 offset:80
    s_waitcnt lgkmcnt(8)
    v_mfma_f32_32x32x16_bf16 v[84:99], v[112:115], v[116:119], v[84:99]
    v_mfma_f32_32x32x16_bf16 v[68:83], v[112:115], v[120:123], v[68:83]
    ds_read_b64 v[112:113], v3 offset:1920
    ds_read_b64 v[114:115], v3 offset:1928
    ds_read_b128 v[116:119], v4 offset:2672
    ds_read_b128 v[120:123], v4 offset:112
    s_waitcnt lgkmcnt(8)
    v_mfma_f32_32x32x16_bf16 v[84:99], v[124:127], v[128:131], v[84:99]
    v_mfma_f32_32x32x16_bf16 v[68:83], v[124:127], v[132:135], v[68:83]
    ds_read_b64 v[124:125], v3 offset:2016
    ds_read_b64 v[126:127], v3 offset:2024
    ds_read_b128 v[128:131], v4 offset:2560
    ds_read_b128 v[132:135], v4 offset:0
    s_waitcnt lgkmcnt(8)
    v_mfma_f32_32x32x16_bf16 v[84:99], v[100:103], v[104:107], v[84:99]
    v_mfma_f32_32x32x16_bf16 v[68:83], v[100:103], v[108:111], v[68:83]
    ds_read_b64 v[100:101], v3 offset:1984
    ds_read_b64 v[102:103], v3 offset:1992
    ds_read_b128 v[104:107], v4 offset:2592
    ds_read_b128 v[108:111], v4 offset:32
    s_waitcnt lgkmcnt(8)
    v_mfma_f32_32x32x16_bf16 v[84:99], v[112:115], v[116:119], v[84:99]
    v_mfma_f32_32x32x16_bf16 v[68:83], v[112:115], v[120:123], v[68:83]
    ds_read_b64 v[112:113], v3 offset:2080
    ds_read_b64 v[114:115], v3 offset:2088
    ds_read_b128 v[116:119], v4 offset:2480
    s_waitcnt lgkmcnt(7)
    v_mfma_f32_32x32x16_bf16 v[84:99], v[124:127], v[128:131], v[84:99]
    v_mfma_f32_32x32x16_bf16 v[68:83], v[124:127], v[132:135], v[68:83]
    ds_read_b64 v[124:125], v3 offset:2048
    ds_read_b64 v[126:127], v3 offset:2056
    ds_read_b128 v[128:131], v4 offset:2512
    s_waitcnt lgkmcnt(6)
    v_mfma_f32_32x32x16_bf16 v[84:99], v[100:103], v[104:107], v[84:99]
    v_mfma_f32_32x32x16_bf16 v[68:83], v[100:103], v[108:111], v[68:83]
    ds_read_b64 v[100:101], v3 offset:2144
    ds_read_b64 v[102:103], v3 offset:2152
    ds_read_b128 v[104:107], v4 offset:2400
    s_waitcnt lgkmcnt(6)
    v_mfma_f32_32x32x16_bf16 v[84:99], v[112:115], v[116:119], v[84:99]
    ds_read_b64 v[112:113], v3 offset:2112
    ds_read_b64 v[114:115], v3 offset:2120
    ds_read_b128 v[116:119], v4 offset:2432
    s_waitcnt lgkmcnt(6)
    v_mfma_f32_32x32x16_bf16 v[84:99], v[124:127], v[128:131], v[84:99]
    ds_read_b64 v[124:125], v3 offset:2208
    ds_read_b64 v[126:127], v3 offset:2216
    ds_read_b128 v[128:131], v4 offset:2320
    s_waitcnt lgkmcnt(6)
    v_mfma_f32_32x32x16_bf16 v[84:99], v[100:103], v[104:107], v[84:99]
    ds_read_b64 v[100:101], v3 offset:2176
    ds_read_b64 v[102:103], v3 offset:2184
    ds_read_b128 v[104:107], v4 offset:2352
    s_waitcnt lgkmcnt(6)
    v_mfma_f32_32x32x16_bf16 v[84:99], v[112:115], v[116:119], v[84:99]
    ds_read_b64 v[112:113], v3 offset:2272
    ds_read_b64 v[114:115], v3 offset:2280
    ds_read_b128 v[116:119], v4 offset:2240
    s_waitcnt lgkmcnt(6)
    v_mfma_f32_32x32x16_bf16 v[84:99], v[124:127], v[128:131], v[84:99]
    ds_read_b64 v[124:125], v3 offset:2240
    ds_read_b64 v[126:127], v3 offset:2248
    ds_read_b128 v[128:131], v4 offset:2272
    s_waitcnt lgkmcnt(6)
    v_mfma_f32_32x32x16_bf16 v[84:99], v[100:103], v[104:107], v[84:99]
    ds_read_b64 v[100:101], v3 offset:2336
    ds_read_b64 v[102:103], v3 offset:2344
    ds_read_b128 v[104:107], v4 offset:2160
    s_waitcnt lgkmcnt(6)
    v_mfma_f32_32x32x16_bf16 v[84:99], v[112:115], v[116:119], v[84:99]
    ds_read_b64 v[112:113], v3 offset:2304
    ds_read_b64 v[114:115], v3 offset:2312
    ds_read_b128 v[116:119], v4 offset:2192
    s_waitcnt lgkmcnt(6)
    v_mfma_f32_32x32x16_bf16 v[84:99], v[124:127], v[128:131], v[84:99]
    ds_read_b64 v[124:125], v3 offset:2400
    ds_read_b64 v[126:127], v3 offset:2408
    ds_read_b128 v[128:131], v4 offset:2080
    s_waitcnt lgkmcnt(6)
    v_mfma_f32_32x32x16_bf16 v[84:99], v[100:103], v[104:107], v[84:99]
    ds_read_b64 v[100:101], v3 offset:2368
    ds_read_b64 v[102:103], v3 offset:2376
    ds_read_b128 v[104:107], v4 offset:2112
    s_waitcnt lgkmcnt(6)
    v_mfma_f32_32x32x16_bf16 v[84:99], v[112:115], v[116:119], v[84:99]
    ds_read_b64 v[112:113], v3 offset:2464
    ds_read_b64 v[114:115], v3 offset:2472
    ds_read_b128 v[116:119], v4 offset:2000
    s_waitcnt lgkmcnt(6)
    v_mfma_f32_32x32x16_bf16 v[84:99], v[124:127], v[128:131], v[84:99]
    ds_read_b64 v[124:125], v3 offset:2432
    ds_read_b64 v[126:127], v3 offset:2440
    ds_read_b128 v[128:131], v4 offset:2032
    s_waitcnt lgkmcnt(6)
    v_mfma_f32_32x32x16_bf16 v[84:99], v[100:103], v[104:107], v[84:99]
    ds_read_b64 v[100:101], v3 offset:2528
    ds_read_b64 v[102:103], v3 offset:2536
    ds_read_b128 v[104:107], v4 offset:1920
    s_waitcnt lgkmcnt(6)
    v_mfma_f32_32x32x16_bf16 v[84:99], v[112:115], v[116:119], v[84:99]
    ds_read_b64 v[112:113], v3 offset:2496
    ds_read_b64 v[114:115], v3 offset:2504
    ds_read_b128 v[116:119], v4 offset:1952
    s_waitcnt lgkmcnt(6)
    v_mfma_f32_32x32x16_bf16 v[84:99], v[124:127], v[128:131], v[84:99]
    ds_read_b64 v[124:125], v3 offset:2592
    ds_read_b64 v[126:127], v3 offset:2600
    ds_read_b128 v[128:131], v4 offset:1840
    s_waitcnt lgkmcnt(6)
    v_mfma_f32_32x32x16_bf16 v[84:99], v[100:103], v[104:107], v[84:99]
    ds_read_b64 v[100:101], v3 offset:2560
    ds_read_b64 v[102:103], v3 offset:2568
    ds_read_b128 v[104:107], v4 offset:1872
    s_waitcnt lgkmcnt(6)
    v_mfma_f32_32x32x16_bf16 v[84:99], v[112:115], v[116:119], v[84:99]
    ds_read_b64 v[112:113], v3 offset:2656
    ds_read_b64 v[114:115], v3 offset:2664
    ds_read_b128 v[116:119], v4 offset:1760
    s_waitcnt lgkmcnt(6)
    v_mfma_f32_32x32x16_bf16 v[84:99], v[124:127], v[128:131], v[84:99]
    ds_read_b64 v[124:125], v3 offset:2624
    ds_read_b64 v[126:127], v3 offset:2632
    ds_read_b128 v[128:131], v4 offset:1792
    s_waitcnt lgkmcnt(6)
    v_mfma_f32_32x32x16_bf16 v[84:99], v[100:103], v[104:107], v[84:99]
    ds_read_b64 v[100:101], v3 offset:2720
    ds_read_b64 v[102:103], v3 offset:2728
    ds_read_b128 v[104:107], v4 offset:1680
    s_waitcnt lgkmcnt(6)
    v_mfma_f32_32x32x16_bf16 v[84:99], v[112:115], v[116:119], v[84:99]
    ds_read_b64 v[112:113], v3 offset:2688
    ds_read_b64 v[114:115], v3 offset:2696
    ds_read_b128 v[116:119], v4 offset:1712
    s_waitcnt lgkmcnt(6)
    v_mfma_f32_32x32x16_bf16 v[84:99], v[124:127], v[128:131], v[84:99]
    ds_read_b64 v[124:125], v3 offset:2784
    ds_read_b64 v[126:127], v3 offset:2792
    ds_read_b128 v[128:131], v4 offset:1600
    s_waitcnt lgkmcnt(6)
    v_mfma_f32_32x32x16_bf16 v[84:99], v[100:103], v[104:107], v[84:99]
    ds_read_b64 v[100:101], v3 offset:2752
    ds_read_b64 v[102:103], v3 offset:2760
    ds_read_b128 v[104:107], v4 offset:1632
    s_waitcnt lgkmcnt(6)
    v_mfma_f32_32x32x16_bf16 v[84:99], v[112:115], v[116:119], v[84:99]
    ds_read_b64 v[112:113], v3 offset:2848
    ds_read_b64 v[114:115], v3 offset:2856
    ds_read_b128 v[116:119], v4 offset:1520
    s_waitcnt lgkmcnt(6)
    v_mfma_f32_32x32x16_bf16 v[84:99], v[124:127], v[128:131], v[84:99]
    ds_read_b64 v[124:125], v3 offset:2816
    ds_read_b64 v[126:127], v3 offset:2824
    ds_read_b128 v[128:131], v4 offset:1552
    s_waitcnt lgkmcnt(6)
    v_mfma_f32_32x32x16_bf16 v[84:99], v[100:103], v[104:107], v[84:99]
    ds_read_b64 v[100:101], v3 offset:2912
    ds_read_b64 v[102:103], v3 offset:2920
    ds_read_b128 v[104:107], v4 offset:1440
    s_waitcnt lgkmcnt(6)
    v_mfma_f32_32x32x16_bf16 v[84:99], v[112:115], v[116:119], v[84:99]
    ds_read_b64 v[112:113], v3 offset:2880
    ds_read_b64 v[114:115], v3 offset:2888
    ds_read_b128 v[116:119], v4 offset:1472
    s_waitcnt lgkmcnt(6)
    v_mfma_f32_32x32x16_bf16 v[84:99], v[124:127], v[128:131], v[84:99]
    ds_read_b64 v[124:125], v3 offset:2976
    ds_read_b64 v[126:127], v3 offset:2984
    ds_read_b128 v[128:131], v4 offset:1360
    s_waitcnt lgkmcnt(6)
    v_mfma_f32_32x32x16_bf16 v[84:99], v[100:103], v[104:107], v[84:99]
    ds_read_b64 v[100:101], v3 offset:2944
    ds_read_b64 v[102:103], v3 offset:2952
    ds_read_b128 v[104:107], v4 offset:1392
    s_waitcnt lgkmcnt(6)
    v_mfma_f32_32x32x16_bf16 v[84:99], v[112:115], v[116:119], v[84:99]
    ds_read_b64 v[112:113], v3 offset:3040
    ds_read_b64 v[114:115], v3 offset:3048
    ds_read_b128 v[116:119], v4 offset:1280
    s_waitcnt lgkmcnt(6)
    v_mfma_f32_32x32x16_bf16 v[84:99], v[124:127], v[128:131], v[84:99]
    ds_read_b64 v[124:125], v3 offset:3008
    ds_read_b64 v[126:127], v3 offset:3016
    ds_read_b128 v[128:131], v4 offset:1312
    s_waitcnt lgkmcnt(6)
    v_mfma_f32_32x32x16_bf16 v[84:99], v[100:103], v[104:107], v[84:99]
    ds_read_b64 v[100:101], v3 offset:3104
    ds_read_b64 v[102:103], v3 offset:3112
    ds_read_b128 v[104:107], v4 offset:1200
    s_waitcnt lgkmcnt(6)
    v_mfma_f32_32x32x16_bf16 v[84:99], v[112:115], v[116:119], v[84:99]
    ds_read_b64 v[112:113], v3 offset:3072
    ds_read_b64 v[114:115], v3 offset:3080
    ds_read_b128 v[116:119], v4 offset:1232
    s_waitcnt lgkmcnt(6)
    v_mfma_f32_32x32x16_bf16 v[84:99], v[124:127], v[128:131], v[84:99]
    ds_read_b64 v[124:125], v3 offset:3168
    ds_read_b64 v[126:127], v3 offset:3176
    ds_read_b128 v[128:131], v4 offset:1120
    s_waitcnt lgkmcnt(6)
    v_mfma_f32_32x32x16_bf16 v[84:99], v[100:103], v[104:107], v[84:99]
    ds_read_b64 v[100:101], v3 offset:3136
    ds_read_b64 v[102:103], v3 offset:3144
    ds_read_b128 v[104:107], v4 offset:1152
    s_waitcnt lgkmcnt(6)
    v_mfma_f32_32x32x16_bf16 v[84:99], v[112:115], v[116:119], v[84:99]
    ds_read_b64 v[112:113], v3 offset:3232
    ds_read_b64 v[114:115], v3 offset:3240
    ds_read_b128 v[116:119], v4 offset:1040
    s_waitcnt lgkmcnt(6)
    v_mfma_f32_32x32x16_bf16 v[84:99], v[124:127], v[128:131], v[84:99]
    ds_read_b64 v[124:125], v3 offset:3200
    ds_read_b64 v[126:127], v3 offset:3208
    ds_read_b128 v[128:131], v4 offset:1072
    s_waitcnt lgkmcnt(6)
    v_mfma_f32_32x32x16_bf16 v[84:99], v[100:103], v[104:107], v[84:99]
    ds_read_b64 v[100:101], v3 offset:3296
    ds_read_b64 v[102:103], v3 offset:3304
    ds_read_b128 v[104:107], v4 offset:960
    s_waitcnt lgkmcnt(6)
    v_mfma_f32_32x32x16_bf16 v[84:99], v[112:115], v[116:119], v[84:99]
    ds_read_b64 v[112:113], v3 offset:3264
    ds_read_b64 v[114:115], v3 offset:3272
    ds_read_b128 v[116:119], v4 offset:992
    s_waitcnt lgkmcnt(6)
    v_mfma_f32_32x32x16_bf16 v[84:99], v[124:127], v[128:131], v[84:99]
    ds_read_b64 v[124:125], v3 offset:3360
    ds_read_b64 v[126:127], v3 offset:3368
    ds_read_b128 v[128:131], v4 offset:880
    s_waitcnt lgkmcnt(6)
    v_mfma_f32_32x32x16_bf16 v[84:99], v[100:103], v[104:107], v[84:99]
    ds_read_b64 v[100:101], v3 offset:3328
    ds_read_b64 v[102:103], v3 offset:3336
    ds_read_b128 v[104:107], v4 offset:912
    s_waitcnt lgkmcnt(6)
    v_mfma_f32_32x32x16_bf16 v[84:99], v[112:115], v[116:119], v[84:99]
    ds_read_b64 v[112:113], v3 offset:3424
    ds_read_b64 v[114:115], v3 offset:3432
    ds_read_b128 v[116:119], v4 offset:800
    s_waitcnt lgkmcnt(6)
    v_mfma_f32_32x32x16_bf16 v[84:99], v[124:127], v[128:131], v[84:99]
    ds_read_b64 v[124:125], v3 offset:3392
    ds_read_b64 v[126:127], v3 offset:3400
    ds_read_b128 v[128:131], v4 offset:832
    s_waitcnt lgkmcnt(6)
    v_mfma_f32_32x32x16_bf16 v[84:99], v[100:103], v[104:107], v[84:99]
    ds_read_b64 v[100:101], v3 offset:3488
    ds_read_b64 v[102:103], v3 offset:3496
    ds_read_b128 v[104:107], v4 offset:720
    s_waitcnt lgkmcnt(6)
    v_mfma_f32_32x32x16_bf16 v[84:99], v[112:115], v[116:119], v[84:99]
    ds_read_b64 v[112:113], v3 offset:3456
    ds_read_b64 v[114:115], v3 offset:3464
    ds_read_b128 v[116:119], v4 offset:752
    s_waitcnt lgkmcnt(6)
    v_mfma_f32_32x32x16_bf16 v[84:99], v[124:127], v[128:131], v[84:99]
    ds_read_b64 v[124:125], v3 offset:3552
    ds_read_b64 v[126:127], v3 offset:3560
    ds_read_b128 v[128:131], v4 offset:640
    s_waitcnt lgkmcnt(6)
    v_mfma_f32_32x32x16_bf16 v[84:99], v[100:103], v[104:107], v[84:99]
    ds_read_b64 v[100:101], v3 offset:3520
    ds_read_b64 v[102:103], v3 offset:3528
    ds_read_b128 v[104:107], v4 offset:672
    s_waitcnt lgkmcnt(6)
    v_mfma_f32_32x32x16_bf16 v[84:99], v[112:115], v[116:119], v[84:99]
    ds_read_b64 v[112:113], v3 offset:3616
    ds_read_b64 v[114:115], v3 offset:3624
    ds_read_b128 v[116:119], v4 offset:560
    s_waitcnt lgkmcnt(6)
    v_mfma_f32_32x32x16_bf16 v[84:99], v[124:127], v[128:131], v[84:99]
    ds_read_b64 v[124:125], v3 offset:3584
    ds_read_b64 v[126:127], v3 offset:3592
    ds_read_b128 v[128:131], v4 offset:592
    s_waitcnt lgkmcnt(6)
    v_mfma_f32_32x32x16_bf16 v[84:99], v[100:103], v[104:107], v[84:99]
    ds_read_b64 v[100:101], v3 offset:3680
    ds_read_b64 v[102:103], v3 offset:3688
    ds_read_b128 v[104:107], v4 offset:480
    s_waitcnt lgkmcnt(6)
    v_mfma_f32_32x32x16_bf16 v[84:99], v[112:115], v[116:119], v[84:99]
    ds_read_b64 v[112:113], v3 offset:3648
    ds_read_b64 v[114:115], v3 offset:3656
    ds_read_b128 v[116:119], v4 offset:512
    s_waitcnt lgkmcnt(6)
    v_mfma_f32_32x32x16_bf16 v[84:99], v[124:127], v[128:131], v[84:99]
    ds_read_b64 v[124:125], v3 offset:3744
    ds_read_b64 v[126:127], v3 offset:3752
    ds_read_b128 v[128:131], v4 offset:400
    s_waitcnt lgkmcnt(6)
    v_mfma_f32_32x32x16_bf16 v[84:99], v[100:103], v[104:107], v[84:99]
    ds_read_b64 v[100:101], v3 offset:3712
    ds_read_b64 v[102:103], v3 offset:3720
    ds_read_b128 v[104:107], v4 offset:432
    s_waitcnt lgkmcnt(6)
    v_mfma_f32_32x32x16_bf16 v[84:99], v[112:115], v[116:119], v[84:99]
    ds_read_b64 v[112:113], v3 offset:3808
    ds_read_b64 v[114:115], v3 offset:3816
    ds_read_b128 v[116:119], v4 offset:320
    s_waitcnt lgkmcnt(6)
    v_mfma_f32_32x32x16_bf16 v[84:99], v[124:127], v[128:131], v[84:99]
    ds_read_b64 v[124:125], v3 offset:3776
    ds_read_b64 v[126:127], v3 offset:3784
    ds_read_b128 v[128:131], v4 offset:352
    s_waitcnt lgkmcnt(6)
    v_mfma_f32_32x32x16_bf16 v[84:99], v[100:103], v[104:107], v[84:99]
    ds_read_b64 v[100:101], v3 offset:3872
    ds_read_b64 v[102:103], v3 offset:3880
    ds_read_b128 v[104:107], v4 offset:240
    s_waitcnt lgkmcnt(6)
    v_mfma_f32_32x32x16_bf16 v[84:99], v[112:115], v[116:119], v[84:99]
    ds_read_b64 v[112:113], v3 offset:3840
    ds_read_b64 v[114:115], v3 offset:3848
    ds_read_b128 v[116:119], v4 offset:272
    s_waitcnt lgkmcnt(6)
    v_mfma_f32_32x32x16_bf16 v[84:99], v[124:127], v[128:131], v[84:99]
    ds_read_b64 v[124:125], v3 offset:3936
    ds_read_b64 v[126:127], v3 offset:3944
    ds_read_b128 v[128:131], v4 offset:160
    s_waitcnt lgkmcnt(6)
    v_mfma_f32_32x32x16_bf16 v[84:99], v[100:103], v[104:107], v[84:99]
    ds_read_b64 v[100:101], v3 offset:3904
    ds_read_b64 v[102:103], v3 offset:3912
    ds_read_b128 v[104:107], v4 offset:192
    s_waitcnt lgkmcnt(6)
    v_mfma_f32_32x32x16_bf16 v[84:99], v[112:115], v[116:119], v[84:99]
    ds_read_b64 v[112:113], v3 offset:4000
    ds_read_b64 v[114:115], v3 offset:4008
    ds_read_b128 v[116:119], v4 offset:80
    s_waitcnt lgkmcnt(6)
    v_mfma_f32_32x32x16_bf16 v[84:99], v[124:127], v[128:131], v[84:99]
    ds_read_b64 v[124:125], v3 offset:3968
    ds_read_b64 v[126:127], v3 offset:3976
    ds_read_b128 v[128:131], v4 offset:112
    s_waitcnt lgkmcnt(6)
    v_mfma_f32_32x32x16_bf16 v[84:99], v[100:103], v[104:107], v[84:99]
    ds_read_b64 v[100:101], v3 offset:4064
    ds_read_b64 v[102:103], v3 offset:4072
    ds_read_b128 v[104:107], v4 offset:0
    s_waitcnt lgkmcnt(6)
    v_mfma_f32_32x32x16_bf16 v[84:99], v[112:115], v[116:119], v[84:99]
    ds_read_b64 v[112:113], v3 offset:4032
    ds_read_b64 v[114:115], v3 offset:4040
    ds_read_b128 v[116:119], v4 offset:32
    s_waitcnt lgkmcnt(6)
    v_mfma_f32_32x32x16_bf16 v[84:99], v[124:127], v[128:131], v[84:99]
    s_waitcnt lgkmcnt(3)
    v_mfma_f32_32x32x16_bf16 v[84:99], v[100:103], v[104:107], v[84:99]
    s_waitcnt lgkmcnt(0)
    v_mfma_f32_32x32x16_bf16 v[84:99], v[112:115], v[116:119], v[84:99]
    s_nop 15
    s_nop 3
    v_cvt_pk_bf16_f32 v10, v68, v69
    v_cvt_pk_bf16_f32 v11, v70, v71
    ds_write_b64 v5, v[10:11] offset:0
    v_cvt_pk_bf16_f32 v10, v72, v73
    v_cvt_pk_bf16_f32 v11, v74, v75
    ds_write_b64 v5, v[10:11] offset:16
    v_cvt_pk_bf16_f32 v10, v76, v77
    v_cvt_pk_bf16_f32 v11, v78, v79
    ds_write_b64 v5, v[10:11] offset:32
    v_cvt_pk_bf16_f32 v10, v80, v81
    v_cvt_pk_bf16_f32 v11, v82, v83
    ds_write_b64 v5, v[10:11] offset:48
    v_cvt_pk_bf16_f32 v10, v84, v85
    v_cvt_pk_bf16_f32 v11, v86, v87
    ds_write_b64 v5, v[10:11] offset:2304
    v_cvt_pk_bf16_f32 v10, v88, v89
    v_cvt_pk_bf16_f32 v11, v90, v91
    ds_write_b64 v5, v[10:11] offset:2320
    v_cvt_pk_bf16_f32 v10, v92, v93
    v_cvt_pk_bf16_f32 v11, v94, v95
    ds_write_b64 v5, v[10:11] offset:2336
    v_cvt_pk_bf16_f32 v10, v96, v97
    v_cvt_pk_bf16_f32 v11, v98, v99
    ds_write_b64 v5, v[10:11] offset:2352
    s_waitcnt lgkmcnt(0)
    s_barrier
    v_lshlrev_b32 v32, 1, v8
    s_lshl_b32 s7, s4, 1
    v_subrev_u32 v32, s7, v32
    s_lshl_b32 s7, s5, 10
    v_add_u32 v32, s7, v32
    s_waitcnt vmcnt(0)
    ds_read_u16 v10, v6 offset:0
    ds_read_u16 v11, v6 offset:25264
    ds_read_u16 v12, v7 offset:0
    ds_read_u16 v13, v7 offset:25264
    s_waitcnt lgkmcnt(0)
    v_lshlrev_b32 v10, 16, v10
    v_lshlrev_b32 v11, 16, v11
    v_lshlrev_b32 v12, 16, v12
    v_lshlrev_b32 v13, 16, v13
    v_lshlrev_b32 v14, 16, v36
    v_and_b32 v15, 0xffff0000, v36
    v_lshlrev_b32 v16, 16, v37
    v_and_b32 v17, 0xffff0000, v37
    v_mul_f32 v14, s80, v14
    v_mul_f32 v15, s81, v15
    v_mul_f32 v16, s82, v16
    v_mul_f32 v17, s83, v17
    v_cvt_pk_bf16_f32 v30, v14, v15
    v_cvt_pk_bf16_f32 v31, v16, v17
    v_lshlrev_b32 v14, 16, v30
    v_and_b32 v15, 0xffff0000, v30
    v_lshlrev_b32 v16, 16, v31
    v_and_b32 v17, 0xffff0000, v31
    v_add_f32 v10, v10, v14
    v_add_f32 v11, v11, v15
    v_add_f32 v12, v12, v16
    v_add_f32 v13, v13, v17
    v_cvt_pk_bf16_f32 v30, v10, v11
    v_cvt_pk_bf16_f32 v31, v12, v13
    v_lshlrev_b32 v10, 16, v30
    v_and_b32 v11, 0xffff0000, v30
    v_lshlrev_b32 v12, 16, v31
    v_and_b32 v13, 0xffff0000, v31
    v_lshlrev_b32 v14, 16, v52
    v_and_b32 v15, 0xffff0000, v52
    v_lshlrev_b32 v16, 16, v53
    v_and_b32 v17, 0xffff0000, v53
    v_mul_f32 v10, v10, v14
    v_mul_f32 v11, v11, v15
    v_mul_f32 v12, v12, v16
    v_mul_f32 v13, v13, v17
    v_cvt_pk_bf16_f32 v18, v10, v11
    v_cvt_pk_bf16_f32 v19, v12, v13
    s_mov_b32 s7, 0
    buffer_store_dwordx2 v[18:19], v32, s[20:23], s7 offen
    ds_read_u16 v10, v6 offset:144
    ds_read_u16 v11, v6 offset:25408
    ds_read_u16 v12, v7 offset:144
    ds_read_u16 v13, v7 offset:25408
    s_waitcnt lgkmcnt(0)
    v_lshlrev_b32 v10, 16, v10
    v_lshlrev_b32 v11, 16, v11
    v_lshlrev_b32 v12, 16, v12
    v_lshlrev_b32 v13, 16, v13
    v_lshlrev_b32 v14, 16, v38
    v_and_b32 v15, 0xffff0000, v38
    v_lshlrev_b32 v16, 16, v39
    v_and_b32 v17, 0xffff0000, v39
    v_mul_f32 v14, s80, v14
    v_mul_f32 v15, s81, v15
    v_mul_f32 v16, s82, v16
    v_mul_f32 v17, s83, v17
    v_cvt_pk_bf16_f32 v30, v14, v15
    v_cvt_pk_bf16_f32 v31, v16, v17
    v_lshlrev_b32 v14, 16, v30
    v_and_b32 v15, 0xffff0000, v30
    v_lshlrev_b32 v16, 16, v31
    v_and_b32 v17, 0xffff0000, v31
    v_add_f32 v10, v10, v14
    v_add_f32 v11, v11, v15
    v_add_f32 v12, v12, v16
    v_add_f32 v13, v13, v17
    v_cvt_pk_bf16_f32 v30, v10, v11
    v_cvt_pk_bf16_f32 v31, v12, v13
    v_lshlrev_b32 v10, 16, v30
    v_and_b32 v11, 0xffff0000, v30
    v_lshlrev_b32 v12, 16, v31
    v_and_b32 v13, 0xffff0000, v31
    v_lshlrev_b32 v14, 16, v54
    v_and_b32 v15, 0xffff0000, v54
    v_lshlrev_b32 v16, 16, v55
    v_and_b32 v17, 0xffff0000, v55
    v_mul_f32 v10, v10, v14
    v_mul_f32 v11, v11, v15
    v_mul_f32 v12, v12, v16
    v_mul_f32 v13, v13, v17
    v_cvt_pk_bf16_f32 v18, v10, v11
    v_cvt_pk_bf16_f32 v19, v12, v13
    s_mov_b32 s7, 131072
    buffer_store_dwordx2 v[18:19], v32, s[20:23], s7 offen
    ds_read_u16 v10, v6 offset:288
    ds_read_u16 v11, v6 offset:25552
    ds_read_u16 v12, v7 offset:288
    ds_read_u16 v13, v7 offset:25552
    s_waitcnt lgkmcnt(0)
    v_lshlrev_b32 v10, 16, v10
    v_lshlrev_b32 v11, 16, v11
    v_lshlrev_b32 v12, 16, v12
    v_lshlrev_b32 v13, 16, v13
    v_lshlrev_b32 v14, 16, v40
    v_and_b32 v15, 0xffff0000, v40
    v_lshlrev_b32 v16, 16, v41
    v_and_b32 v17, 0xffff0000, v41
    v_mul_f32 v14, s80, v14
    v_mul_f32 v15, s81, v15
    v_mul_f32 v16, s82, v16
    v_mul_f32 v17, s83, v17
    v_cvt_pk_bf16_f32 v30, v14, v15
    v_cvt_pk_bf16_f32 v31, v16, v17
    v_lshlrev_b32 v14, 16, v30
    v_and_b32 v15, 0xffff0000, v30
    v_lshlrev_b32 v16, 16, v31
    v_and_b32 v17, 0xffff0000, v31
    v_add_f32 v10, v10, v14
    v_add_f32 v11, v11, v15
    v_add_f32 v12, v12, v16
    v_add_f32 v13, v13, v17
    v_cvt_pk_bf16_f32 v30, v10, v11
    v_cvt_pk_bf16_f32 v31, v12, v13
    v_lshlrev_b32 v10, 16, v30
    v_and_b32 v11, 0xffff0000, v30
    v_lshlrev_b32 v12, 16, v31
    v_and_b32 v13, 0xffff0000, v31
    v_lshlrev_b32 v14, 16, v56
    v_and_b32 v15, 0xffff0000, v56
    v_lshlrev_b32 v16, 16, v57
    v_and_b32 v17, 0xffff0000, v57
    v_mul_f32 v10, v10, v14
    v_mul_f32 v11, v11, v15
    v_mul_f32 v12, v12, v16
    v_mul_f32 v13, v13, v17
    v_cvt_pk_bf16_f32 v18, v10, v11
    v_cvt_pk_bf16_f32 v19, v12, v13
    s_mov_b32 s7, 262144
    buffer_store_dwordx2 v[18:19], v32, s[20:23], s7 offen
    ds_read_u16 v10, v6 offset:432
    ds_read_u16 v11, v6 offset:25696
    ds_read_u16 v12, v7 offset:432
    ds_read_u16 v13, v7 offset:25696
    s_waitcnt lgkmcnt(0)
    v_lshlrev_b32 v10, 16, v10
    v_lshlrev_b32 v11, 16, v11
    v_lshlrev_b32 v12, 16, v12
    v_lshlrev_b32 v13, 16, v13
    v_lshlrev_b32 v14, 16, v42
    v_and_b32 v15, 0xffff0000, v42
    v_lshlrev_b32 v16, 16, v43
    v_and_b32 v17, 0xffff0000, v43
    v_mul_f32 v14, s80, v14
    v_mul_f32 v15, s81, v15
    v_mul_f32 v16, s82, v16
    v_mul_f32 v17, s83, v17
    v_cvt_pk_bf16_f32 v30, v14, v15
    v_cvt_pk_bf16_f32 v31, v16, v17
    v_lshlrev_b32 v14, 16, v30
    v_and_b32 v15, 0xffff0000, v30
    v_lshlrev_b32 v16, 16, v31
    v_and_b32 v17, 0xffff0000, v31
    v_add_f32 v10, v10, v14
    v_add_f32 v11, v11, v15
    v_add_f32 v12, v12, v16
    v_add_f32 v13, v13, v17
    v_cvt_pk_bf16_f32 v30, v10, v11
    v_cvt_pk_bf16_f32 v31, v12, v13
    v_lshlrev_b32 v10, 16, v30
    v_and_b32 v11, 0xffff0000, v30
    v_lshlrev_b32 v12, 16, v31
    v_and_b32 v13, 0xffff0000, v31
    v_lshlrev_b32 v14, 16, v58
    v_and_b32 v15, 0xffff0000, v58
    v_lshlrev_b32 v16, 16, v59
    v_and_b32 v17, 0xffff0000, v59
    v_mul_f32 v10, v10, v14
    v_mul_f32 v11, v11, v15
    v_mul_f32 v12, v12, v16
    v_mul_f32 v13, v13, v17
    v_cvt_pk_bf16_f32 v18, v10, v11
    v_cvt_pk_bf16_f32 v19, v12, v13
    s_mov_b32 s7, 393216
    buffer_store_dwordx2 v[18:19], v32, s[20:23], s7 offen
    ds_read_u16 v10, v6 offset:576
    ds_read_u16 v11, v6 offset:25840
    ds_read_u16 v12, v7 offset:576
    ds_read_u16 v13, v7 offset:25840
    s_waitcnt lgkmcnt(0)
    v_lshlrev_b32 v10, 16, v10
    v_lshlrev_b32 v11, 16, v11
    v_lshlrev_b32 v12, 16, v12
    v_lshlrev_b32 v13, 16, v13
    v_lshlrev_b32 v14, 16, v44
    v_and_b32 v15, 0xffff0000, v44
    v_lshlrev_b32 v16, 16, v45
    v_and_b32 v17, 0xffff0000, v45
    v_mul_f32 v14, s80, v14
    v_mul_f32 v15, s81, v15
    v_mul_f32 v16, s82, v16
    v_mul_f32 v17, s83, v17
    v_cvt_pk_bf16_f32 v30, v14, v15
    v_cvt_pk_bf16_f32 v31, v16, v17
    v_lshlrev_b32 v14, 16, v30
    v_and_b32 v15, 0xffff0000, v30
    v_lshlrev_b32 v16, 16, v31
    v_and_b32 v17, 0xffff0000, v31
    v_add_f32 v10, v10, v14
    v_add_f32 v11, v11, v15
    v_add_f32 v12, v12, v16
    v_add_f32 v13, v13, v17
    v_cvt_pk_bf16_f32 v30, v10, v11
    v_cvt_pk_bf16_f32 v31, v12, v13
    v_lshlrev_b32 v10, 16, v30
    v_and_b32 v11, 0xffff0000, v30
    v_lshlrev_b32 v12, 16, v31
    v_and_b32 v13, 0xffff0000, v31
    v_lshlrev_b32 v14, 16, v60
    v_and_b32 v15, 0xffff0000, v60
    v_lshlrev_b32 v16, 16, v61
    v_and_b32 v17, 0xffff0000, v61
    v_mul_f32 v10, v10, v14
    v_mul_f32 v11, v11, v15
    v_mul_f32 v12, v12, v16
    v_mul_f32 v13, v13, v17
    v_cvt_pk_bf16_f32 v18, v10, v11
    v_cvt_pk_bf16_f32 v19, v12, v13
    s_mov_b32 s7, 524288
    buffer_store_dwordx2 v[18:19], v32, s[20:23], s7 offen
    ds_read_u16 v10, v6 offset:720
    ds_read_u16 v11, v6 offset:25984
    ds_read_u16 v12, v7 offset:720
    ds_read_u16 v13, v7 offset:25984
    s_waitcnt lgkmcnt(0)
    v_lshlrev_b32 v10, 16, v10
    v_lshlrev_b32 v11, 16, v11
    v_lshlrev_b32 v12, 16, v12
    v_lshlrev_b32 v13, 16, v13
    v_lshlrev_b32 v14, 16, v46
    v_and_b32 v15, 0xffff0000, v46
    v_lshlrev_b32 v16, 16, v47
    v_and_b32 v17, 0xffff0000, v47
    v_mul_f32 v14, s80, v14
    v_mul_f32 v15, s81, v15
    v_mul_f32 v16, s82, v16
    v_mul_f32 v17, s83, v17
    v_cvt_pk_bf16_f32 v30, v14, v15
    v_cvt_pk_bf16_f32 v31, v16, v17
    v_lshlrev_b32 v14, 16, v30
    v_and_b32 v15, 0xffff0000, v30
    v_lshlrev_b32 v16, 16, v31
    v_and_b32 v17, 0xffff0000, v31
    v_add_f32 v10, v10, v14
    v_add_f32 v11, v11, v15
    v_add_f32 v12, v12, v16
    v_add_f32 v13, v13, v17
    v_cvt_pk_bf16_f32 v30, v10, v11
    v_cvt_pk_bf16_f32 v31, v12, v13
    v_lshlrev_b32 v10, 16, v30
    v_and_b32 v11, 0xffff0000, v30
    v_lshlrev_b32 v12, 16, v31
    v_and_b32 v13, 0xffff0000, v31
    v_lshlrev_b32 v14, 16, v62
    v_and_b32 v15, 0xffff0000, v62
    v_lshlrev_b32 v16, 16, v63
    v_and_b32 v17, 0xffff0000, v63
    v_mul_f32 v10, v10, v14
    v_mul_f32 v11, v11, v15
    v_mul_f32 v12, v12, v16
    v_mul_f32 v13, v13, v17
    v_cvt_pk_bf16_f32 v18, v10, v11
    v_cvt_pk_bf16_f32 v19, v12, v13
    s_mov_b32 s7, 655360
    buffer_store_dwordx2 v[18:19], v32, s[20:23], s7 offen
    ds_read_u16 v10, v6 offset:864
    ds_read_u16 v11, v6 offset:26128
    ds_read_u16 v12, v7 offset:864
    ds_read_u16 v13, v7 offset:26128
    s_waitcnt lgkmcnt(0)
    v_lshlrev_b32 v10, 16, v10
    v_lshlrev_b32 v11, 16, v11
    v_lshlrev_b32 v12, 16, v12
    v_lshlrev_b32 v13, 16, v13
    v_lshlrev_b32 v14, 16, v48
    v_and_b32 v15, 0xffff0000, v48
    v_lshlrev_b32 v16, 16, v49
    v_and_b32 v17, 0xffff0000, v49
    v_mul_f32 v14, s80, v14
    v_mul_f32 v15, s81, v15
    v_mul_f32 v16, s82, v16
    v_mul_f32 v17, s83, v17
    v_cvt_pk_bf16_f32 v30, v14, v15
    v_cvt_pk_bf16_f32 v31, v16, v17
    v_lshlrev_b32 v14, 16, v30
    v_and_b32 v15, 0xffff0000, v30
    v_lshlrev_b32 v16, 16, v31
    v_and_b32 v17, 0xffff0000, v31
    v_add_f32 v10, v10, v14
    v_add_f32 v11, v11, v15
    v_add_f32 v12, v12, v16
    v_add_f32 v13, v13, v17
    v_cvt_pk_bf16_f32 v30, v10, v11
    v_cvt_pk_bf16_f32 v31, v12, v13
    v_lshlrev_b32 v10, 16, v30
    v_and_b32 v11, 0xffff0000, v30
    v_lshlrev_b32 v12, 16, v31
    v_and_b32 v13, 0xffff0000, v31
    v_lshlrev_b32 v14, 16, v64
    v_and_b32 v15, 0xffff0000, v64
    v_lshlrev_b32 v16, 16, v65
    v_and_b32 v17, 0xffff0000, v65
    v_mul_f32 v10, v10, v14
    v_mul_f32 v11, v11, v15
    v_mul_f32 v12, v12, v16
    v_mul_f32 v13, v13, v17
    v_cvt_pk_bf16_f32 v18, v10, v11
    v_cvt_pk_bf16_f32 v19, v12, v13
    s_mov_b32 s7, 786432
    buffer_store_dwordx2 v[18:19], v32, s[20:23], s7 offen
    ds_read_u16 v10, v6 offset:1008
    ds_read_u16 v11, v6 offset:26272
    ds_read_u16 v12, v7 offset:1008
    ds_read_u16 v13, v7 offset:26272
    s_waitcnt lgkmcnt(0)
    v_lshlrev_b32 v10, 16, v10
    v_lshlrev_b32 v11, 16, v11
    v_lshlrev_b32 v12, 16, v12
    v_lshlrev_b32 v13, 16, v13
    v_lshlrev_b32 v14, 16, v50
    v_and_b32 v15, 0xffff0000, v50
    v_lshlrev_b32 v16, 16, v51
    v_and_b32 v17, 0xffff0000, v51
    v_mul_f32 v14, s80, v14
    v_mul_f32 v15, s81, v15
    v_mul_f32 v16, s82, v16
    v_mul_f32 v17, s83, v17
    v_cvt_pk_bf16_f32 v30, v14, v15
    v_cvt_pk_bf16_f32 v31, v16, v17
    v_lshlrev_b32 v14, 16, v30
    v_and_b32 v15, 0xffff0000, v30
    v_lshlrev_b32 v16, 16, v31
    v_and_b32 v17, 0xffff0000, v31
    v_add_f32 v10, v10, v14
    v_add_f32 v11, v11, v15
    v_add_f32 v12, v12, v16
    v_add_f32 v13, v13, v17
    v_cvt_pk_bf16_f32 v30, v10, v11
    v_cvt_pk_bf16_f32 v31, v12, v13
    v_lshlrev_b32 v10, 16, v30
    v_and_b32 v11, 0xffff0000, v30
    v_lshlrev_b32 v12, 16, v31
    v_and_b32 v13, 0xffff0000, v31
    v_lshlrev_b32 v14, 16, v66
    v_and_b32 v15, 0xffff0000, v66
    v_lshlrev_b32 v16, 16, v67
    v_and_b32 v17, 0xffff0000, v67
    v_mul_f32 v10, v10, v14
    v_mul_f32 v11, v11, v15
    v_mul_f32 v12, v12, v16
    v_mul_f32 v13, v13, v17
    v_cvt_pk_bf16_f32 v18, v10, v11
    v_cvt_pk_bf16_f32 v19, v12, v13
    s_mov_b32 s7, 917504
    buffer_store_dwordx2 v[18:19], v32, s[20:23], s7 offen
    s_branch L_end
L_A:
    v_mov_b32 v10, 0
    v_mov_b32 v11, 0
    v_mov_b32 v12, 0
    v_mov_b32 v13, 0
    v_lshlrev_b32 v14, 4, v0
    v_add_u32 v14, s6, v14
    ds_write_b128 v14, v[10:13] offset:17664
    ds_write_b128 v14, v[10:13] offset:18688
    ds_write_b128 v14, v[10:13] offset:19712
    v_mov_b32 v15, 0x33333334
    v_mul_hi_u32 v15, v15, v0
    v_mul_u32_u24 v16, 5, v15
    v_sub_u32 v16, v0, v16
    v_mul_u32_u24 v15, 4416, v15
    v_lshlrev_b32 v16, 4, v16
    v_add3_u32 v15, v15, v16, s6
    v_cmp_gt_u32 vcc, 20, v0
    s_and_saveexec_b64 s[26:27], vcc
    ds_write_b128 v15, v[10:13] offset:0
    s_mov_b64 exec, s[26:27]
    s_mov_b32 s8, s32
    s_and_b32 s9, s33, 0xffff
    s_mov_b32 s10, 0x200000
    s_mov_b32 s11, 0x00020000
    s_mov_b32 s7, 0
    buffer_load_dwordx2 v[36:37], v8, s[8:11], s7 offen
    s_mov_b32 s7, 65536
    buffer_load_dwordx2 v[38:39], v8, s[8:11], s7 offen
    s_mov_b32 s7, 131072
    buffer_load_dwordx2 v[40:41], v8, s[8:11], s7 offen
    s_mov_b32 s7, 196608
    buffer_load_dwordx2 v[42:43], v8, s[8:11], s7 offen
    s_mov_b32 s7, 262144
    buffer_load_dwordx2 v[44:45], v8, s[8:11], s7 offen
    s_mov_b32 s7, 327680
    buffer_load_dwordx2 v[46:47], v8, s[8:11], s7 offen
    s_mov_b32 s7, 393216
    buffer_load_dwordx2 v[48:49], v8, s[8:11], s7 offen
    s_mov_b32 s7, 458752
    buffer_load_dwordx2 v[50:51], v8, s[8:11], s7 offen
    s_lshl_b32 s7, s4, 1
    s_add_u32 s44, s44, s7
    s_addc_u32 s45, s45, 0
    s_load_dwordx2 s[92:93], s[44:45], 0
    s_add_u32 s24, s4, s3
    s_mov_b32 s12, s34
    s_and_b32 s13, s35, 0xffff
    s_mov_b32 s14, 0x20000
    s_mov_b32 s15, 0x00020000
    s_mov_b32 s16, s36
    s_and_b32 s17, s37, 0xffff
    s_mov_b32 s18, 0x20000
    s_mov_b32 s19, 0x00020000
    s_lshl_b32 s7, s24, 8
    v_lshlrev_b32 v10, 2, v0
    v_add_u32 v10, s7, v10
    buffer_load_dword v11, v10, s[12:15], 0 offen
    buffer_load_dword v12, v10, s[16:19], 0 offen
    s_mov_b32 s12, s38
    s_and_b32 s13, s39, 0xffff
    s_mov_b32 s14, 0x20000
    s_mov_b32 s15, 0x00020000
    s_mov_b32 s16, s40
    s_and_b32 s17, s41, 0xffff
    s_mov_b32 s18, 0x20000
    s_mov_b32 s19, 0x00020000
    buffer_load_dword v13, v10, s[12:15], 0 offen
    buffer_load_dword v14, v10, s[16:19], 0 offen
    s_mov_b32 s12, s42
    s_and_b32 s13, s43, 0xffff
    s_mov_b32 s14, 0x400
    s_mov_b32 s15, 0x00020000
    s_lshl_b32 s7, s24, 1
    v_mov_b32 v15, s7
    buffer_load_ushort v15, v15, s[12:15], 0 offen
    s_waitcnt lgkmcnt(0)
    s_lshl_b32 s80, s92, 16
    s_and_b32 s81, s92, 0xffff0000
    s_lshl_b32 s82, s93, 16
    s_and_b32 s83, s93, 0xffff0000
    s_waitcnt vmcnt(0)
    v_lshlrev_b32 v15, 16, v15
    v_mul_f32 v15, 0x3fb8aa3b, v15
    v_exp_f32 v15, v15
    s_nop 0
    v_cvt_pk_bf16_f32 v15, v15, v15
    v_and_b32 v15, 0xffff0000, v15
    v_lshlrev_b32 v16, 5, v0
    v_add_u32 v16, 101056, v16
    s_lshl_b32 s7, s3, 11
    v_add_u32 v16, s7, v16
    v_lshlrev_b32 v18, 16, v11
    v_lshlrev_b32 v19, 16, v12
    v_lshlrev_b32 v20, 16, v13
    v_lshlrev_b32 v21, 16, v14
    v_mul_f32 v18, 0x3fb8aa3b, v18
    v_exp_f32 v18, v18
    s_nop 0
    v_cvt_pk_bf16_f32 v18, v18, v18
    v_and_b32 v18, 0xffff0000, v18
    v_mul_f32 v18, v18, v15
    v_mul_f32 v18, 0xbfb8aa3b, v18
    v_mul_f32 v19, v19, v15
    v_mul_f32 v19, 0.15915494, v19
    v_mul_f32 v20, v20, v15
    v_mul_f32 v21, v21, v15
    ds_write_b128 v16, v[18:21] offset:0
    v_and_b32 v18, 0xffff0000, v11
    v_and_b32 v19, 0xffff0000, v12
    v_and_b32 v20, 0xffff0000, v13
    v_and_b32 v21, 0xffff0000, v14
    v_mul_f32 v18, 0x3fb8aa3b, v18
    v_exp_f32 v18, v18
    s_nop 0
    v_cvt_pk_bf16_f32 v18, v18, v18
    v_and_b32 v18, 0xffff0000, v18
    v_mul_f32 v18, v18, v15
    v_mul_f32 v18, 0xbfb8aa3b, v18
    v_mul_f32 v19, v19, v15
    v_mul_f32 v19, 0.15915494, v19
    v_mul_f32 v20, v20, v15
    v_mul_f32 v21, v21, v15
    ds_write_b128 v16, v[18:21] offset:16
    v_and_b32 v13, 31, v0
    v_lshlrev_b32 v11, 3, v13
    v_cvt_f32_u32 v11, v11
    v_mov_b32 v12, 0
    v_cmp_eq_u32 vcc, 1, v13
    v_mov_b32 v14, 1
    s_nop 0
    v_cndmask_b32 v12, v12, v14, vcc
    v_cmp_eq_u32 vcc, 2, v13
    v_mov_b32 v14, 2
    s_nop 0
    v_cndmask_b32 v12, v12, v14, vcc
    v_cmp_eq_u32 vcc, 3, v13
    v_mov_b32 v14, 3
    s_nop 0
    v_cndmask_b32 v12, v12, v14, vcc
    v_cmp_eq_u32 vcc, 4, v13
    v_mov_b32 v14, 4
    s_nop 0
    v_cndmask_b32 v12, v12, v14, vcc
    v_cmp_eq_u32 vcc, 5, v13
    v_mov_b32 v14, 5
    s_nop 0
    v_cndmask_b32 v12, v12, v14, vcc
    v_cmp_eq_u32 vcc, 6, v13
    v_mov_b32 v14, 6
    s_nop 0
    v_cndmask_b32 v12, v12, v14, vcc
    v_cmp_eq_u32 vcc, 7, v13
    v_mov_b32 v14, 7
    s_nop 0
    v_cndmask_b32 v12, v12, v14, vcc
    v_cmp_eq_u32 vcc, 8, v13
    v_mov_b32 v14, 256
    s_nop 0
    v_cndmask_b32 v12, v12, v14, vcc
    v_cmp_eq_u32 vcc, 9, v13
    v_mov_b32 v14, 258
    s_nop 0
    v_cndmask_b32 v12, v12, v14, vcc
    v_cmp_eq_u32 vcc, 10, v13
    v_mov_b32 v14, 260
    s_nop 0
    v_cndmask_b32 v12, v12, v14, vcc
    v_cmp_eq_u32 vcc, 11, v13
    v_mov_b32 v14, 262
    s_nop 0
    v_cndmask_b32 v12, v12, v14, vcc
    v_cmp_eq_u32 vcc, 12, v13
    v_mov_b32 v14, 512
    s_nop 0
    v_cndmask_b32 v12, v12, v14, vcc
    v_cmp_eq_u32 vcc, 13, v13
    v_mov_b32 v14, 516
    s_nop 0
    v_cndmask_b32 v12, v12, v14, vcc
    v_cmp_eq_u32 vcc, 14, v13
    v_mov_b32 v14, 768
    s_nop 0
    v_cndmask_b32 v12, v12, v14, vcc
    v_cmp_eq_u32 vcc, 15, v13
    v_mov_b32 v14, 772
    s_nop 0
    v_cndmask_b32 v12, v12, v14, vcc
    v_cmp_eq_u32 vcc, 16, v13
    v_mov_b32 v14, 1024
    s_nop 0
    v_cndmask_b32 v12, v12, v14, vcc
    v_cmp_eq_u32 vcc, 17, v13
    v_mov_b32 v14, 1280
    s_nop 0
    v_cndmask_b32 v12, v12, v14, vcc
    v_cmp_eq_u32 vcc, 18, v13
    v_mov_b32 v14, 1536
    s_nop 0
    v_cndmask_b32 v12, v12, v14, vcc
    v_cmp_eq_u32 vcc, 19, v13
    v_mov_b32 v14, 1792
    s_nop 0
    v_cndmask_b32 v12, v12, v14, vcc
    v_cmp_eq_u32 vcc, 20, v13
    v_mov_b32 v14, 2048
    s_nop 0
    v_cndmask_b32 v12, v12, v14, vcc
    v_cvt_f32_u32 v12, v12
    v_lshrrev_b32 v14, 5, v0
    v_lshlrev_b32 v14, 10, v14
    v_add_u32 v14, 101056, v14
    v_add_u32 v14, s7, v14
    v_mov_b32 v68, 0
    v_mov_b32 v69, 0
    v_mov_b32 v70, 0
    v_mov_b32 v71, 0
    v_mov_b32 v72, 0
    v_mov_b32 v73, 0
    v_mov_b32 v74, 0
    v_mov_b32 v75, 0
    v_mov_b32 v76, 0
    v_mov_b32 v77, 0
    v_mov_b32 v78, 0
    v_mov_b32 v79, 0
    v_mov_b32 v80, 0
    v_mov_b32 v81, 0
    v_mov_b32 v82, 0
    v_mov_b32 v83, 0
    s_waitcnt lgkmcnt(0)
    ds_read_b128 v[116:119], v14 offset:0
    ds_read_b128 v[120:123], v14 offset:16
    ds_read_b128 v[124:127], v14 offset:32
    ds_read_b128 v[128:131], v14 offset:48
    s_waitcnt lgkmcnt(0)
    v_mul_f32 v16, v116, v11
    v_mul_f32 v17, v117, v11
    v_exp_f32 v16, v16
    v_fract_f32 v17, v17
    v_mul_f32 v20, v116, v12
    v_mul_f32 v21, v117, v12
    v_cos_f32 v18, v17
    v_sin_f32 v19, v17
    v_exp_f32 v20, v20
    v_fract_f32 v21, v21
    v_mul_f32 v18, v16, v18
    v_mul_f32 v19, v16, v19
    v_cos_f32 v22, v21
    v_sin_f32 v23, v21
    v_cvt_pk_bf16_f32 v108, v18, v19
    v_lshlrev_b32 v24, 16, v108
    v_and_b32 v25, 0xffff0000, v108
    v_sub_f32 v18, v18, v24
    v_sub_f32 v19, v19, v25
    v_cvt_pk_bf16_f32 v112, v18, v19
    v_mul_f32 v22, v20, v22
    v_mul_f32 v23, v20, v23
    v_mul_f32 v24, v118, v22
    v_fma_f32 v24, -v119, v23, v24
    v_mul_f32 v25, v118, v23
    v_fma_f32 v25, v119, v22, v25
    v_xor_b32 v25, 0x80000000, v25
    v_cvt_pk_bf16_f32 v100, v24, v25
    v_lshlrev_b32 v26, 16, v100
    v_and_b32 v27, 0xffff0000, v100
    v_sub_f32 v24, v24, v26
    v_sub_f32 v25, v25, v27
    v_cvt_pk_bf16_f32 v104, v24, v25
    v_mul_f32 v16, v120, v11
    v_mul_f32 v17, v121, v11
    v_exp_f32 v16, v16
    v_fract_f32 v17, v17
    v_mul_f32 v20, v120, v12
    v_mul_f32 v21, v121, v12
    v_cos_f32 v18, v17
    v_sin_f32 v19, v17
    v_exp_f32 v20, v20
    v_fract_f32 v21, v21
    v_mul_f32 v18, v16, v18
    v_mul_f32 v19, v16, v19
    v_cos_f32 v22, v21
    v_sin_f32 v23, v21
    v_cvt_pk_bf16_f32 v109, v18, v19
    v_lshlrev_b32 v24, 16, v109
    v_and_b32 v25, 0xffff0000, v109
    v_sub_f32 v18, v18, v24
    v_sub_f32 v19, v19, v25
    v_cvt_pk_bf16_f32 v113, v18, v19
    v_mul_f32 v22, v20, v22
    v_mul_f32 v23, v20, v23
    v_mul_f32 v24, v122, v22
    v_fma_f32 v24, -v123, v23, v24
    v_mul_f32 v25, v122, v23
    v_fma_f32 v25, v123, v22, v25
    v_xor_b32 v25, 0x80000000, v25
    v_cvt_pk_bf16_f32 v101, v24, v25
    v_lshlrev_b32 v26, 16, v101
    v_and_b32 v27, 0xffff0000, v101
    v_sub_f32 v24, v24, v26
    v_sub_f32 v25, v25, v27
    v_cvt_pk_bf16_f32 v105, v24, v25
    v_mul_f32 v16, v124, v11
    v_mul_f32 v17, v125, v11
    v_exp_f32 v16, v16
    v_fract_f32 v17, v17
    v_mul_f32 v20, v124, v12
    v_mul_f32 v21, v125, v12
    v_cos_f32 v18, v17
    v_sin_f32 v19, v17
    v_exp_f32 v20, v20
    v_fract_f32 v21, v21
    v_mul_f32 v18, v16, v18
    v_mul_f32 v19, v16, v19
    v_cos_f32 v22, v21
    v_sin_f32 v23, v21
    v_cvt_pk_bf16_f32 v110, v18, v19
    v_lshlrev_b32 v24, 16, v110
    v_and_b32 v25, 0xffff0000, v110
    v_sub_f32 v18, v18, v24
    v_sub_f32 v19, v19, v25
    v_cvt_pk_bf16_f32 v114, v18, v19
    v_mul_f32 v22, v20, v22
    v_mul_f32 v23, v20, v23
    v_mul_f32 v24, v126, v22
    v_fma_f32 v24, -v127, v23, v24
    v_mul_f32 v25, v126, v23
    v_fma_f32 v25, v127, v22, v25
    v_xor_b32 v25, 0x80000000, v25
    v_cvt_pk_bf16_f32 v102, v24, v25
    v_lshlrev_b32 v26, 16, v102
    v_and_b32 v27, 0xffff0000, v102
    v_sub_f32 v24, v24, v26
    v_sub_f32 v25, v25, v27
    v_cvt_pk_bf16_f32 v106, v24, v25
    v_mul_f32 v16, v128, v11
    v_mul_f32 v17, v129, v11
    v_exp_f32 v16, v16
    v_fract_f32 v17, v17
    v_mul_f32 v20, v128, v12
    v_mul_f32 v21, v129, v12
    v_cos_f32 v18, v17
    v_sin_f32 v19, v17
    v_exp_f32 v20, v20
    v_fract_f32 v21, v21
    v_mul_f32 v18, v16, v18
    v_mul_f32 v19, v16, v19
    v_cos_f32 v22, v21
    v_sin_f32 v23, v21
    v_cvt_pk_bf16_f32 v111, v18, v19
    v_lshlrev_b32 v24, 16, v111
    v_and_b32 v25, 0xffff0000, v111
    v_sub_f32 v18, v18, v24
    v_sub_f32 v19, v19, v25
    v_cvt_pk_bf16_f32 v115, v18, v19
    v_mul_f32 v22, v20, v22
    v_mul_f32 v23, v20, v23
    v_mul_f32 v24, v130, v22
    v_fma_f32 v24, -v131, v23, v24
    v_mul_f32 v25, v130, v23
    v_fma_f32 v25, v131, v22, v25
    v_xor_b32 v25, 0x80000000, v25
    v_cvt_pk_bf16_f32 v103, v24, v25
    v_lshlrev_b32 v26, 16, v103
    v_and_b32 v27, 0xffff0000, v103
    v_sub_f32 v24, v24, v26
    v_sub_f32 v25, v25, v27
    v_cvt_pk_bf16_f32 v107, v24, v25
    s_nop 1
    v_mfma_f32_32x32x16_bf16 v[68:83], v[100:103], v[108:111], v[68:83]
    v_mfma_f32_32x32x16_bf16 v[68:83], v[100:103], v[112:115], v[68:83]
    v_mfma_f32_32x32x16_bf16 v[68:83], v[104:107], v[108:111], v[68:83]
    ds_read_b128 v[116:119], v14 offset:64
    ds_read_b128 v[120:123], v14 offset:80
    ds_read_b128 v[124:127], v14 offset:96
    ds_read_b128 v[128:131], v14 offset:112
    s_waitcnt lgkmcnt(0)
    v_mul_f32 v16, v116, v11
    v_mul_f32 v17, v117, v11
    v_exp_f32 v16, v16
    v_fract_f32 v17, v17
    v_mul_f32 v20, v116, v12
    v_mul_f32 v21, v117, v12
    v_cos_f32 v18, v17
    v_sin_f32 v19, v17
    v_exp_f32 v20, v20
    v_fract_f32 v21, v21
    v_mul_f32 v18, v16, v18
    v_mul_f32 v19, v16, v19
    v_cos_f32 v22, v21
    v_sin_f32 v23, v21
    v_cvt_pk_bf16_f32 v108, v18, v19
    v_lshlrev_b32 v24, 16, v108
    v_and_b32 v25, 0xffff0000, v108
    v_sub_f32 v18, v18, v24
    v_sub_f32 v19, v19, v25
    v_cvt_pk_bf16_f32 v112, v18, v19
    v_mul_f32 v22, v20, v22
    v_mul_f32 v23, v20, v23
    v_mul_f32 v24, v118, v22
    v_fma_f32 v24, -v119, v23, v24
    v_mul_f32 v25, v118, v23
    v_fma_f32 v25, v119, v22, v25
    v_xor_b32 v25, 0x80000000, v25
    v_cvt_pk_bf16_f32 v100, v24, v25
    v_lshlrev_b32 v26, 16, v100
    v_and_b32 v27, 0xffff0000, v100
    v_sub_f32 v24, v24, v26
    v_sub_f32 v25, v25, v27
    v_cvt_pk_bf16_f32 v104, v24, v25
    v_mul_f32 v16, v120, v11
    v_mul_f32 v17, v121, v11
    v_exp_f32 v16, v16
    v_fract_f32 v17, v17
    v_mul_f32 v20, v120, v12
    v_mul_f32 v21, v121, v12
    v_cos_f32 v18, v17
    v_sin_f32 v19, v17
    v_exp_f32 v20, v20
    v_fract_f32 v21, v21
    v_mul_f32 v18, v16, v18
    v_mul_f32 v19, v16, v19
    v_cos_f32 v22, v21
    v_sin_f32 v23, v21
    v_cvt_pk_bf16_f32 v109, v18, v19
    v_lshlrev_b32 v24, 16, v109
    v_and_b32 v25, 0xffff0000, v109
    v_sub_f32 v18, v18, v24
    v_sub_f32 v19, v19, v25
    v_cvt_pk_bf16_f32 v113, v18, v19
    v_mul_f32 v22, v20, v22
    v_mul_f32 v23, v20, v23
    v_mul_f32 v24, v122, v22
    v_fma_f32 v24, -v123, v23, v24
    v_mul_f32 v25, v122, v23
    v_fma_f32 v25, v123, v22, v25
    v_xor_b32 v25, 0x80000000, v25
    v_cvt_pk_bf16_f32 v101, v24, v25
    v_lshlrev_b32 v26, 16, v101
    v_and_b32 v27, 0xffff0000, v101
    v_sub_f32 v24, v24, v26
    v_sub_f32 v25, v25, v27
    v_cvt_pk_bf16_f32 v105, v24, v25
    v_mul_f32 v16, v124, v11
    v_mul_f32 v17, v125, v11
    v_exp_f32 v16, v16
    v_fract_f32 v17, v17
    v_mul_f32 v20, v124, v12
    v_mul_f32 v21, v125, v12
    v_cos_f32 v18, v17
    v_sin_f32 v19, v17
    v_exp_f32 v20, v20
    v_fract_f32 v21, v21
    v_mul_f32 v18, v16, v18
    v_mul_f32 v19, v16, v19
    v_cos_f32 v22, v21
    v_sin_f32 v23, v21
    v_cvt_pk_bf16_f32 v110, v18, v19
    v_lshlrev_b32 v24, 16, v110
    v_and_b32 v25, 0xffff0000, v110
    v_sub_f32 v18, v18, v24
    v_sub_f32 v19, v19, v25
    v_cvt_pk_bf16_f32 v114, v18, v19
    v_mul_f32 v22, v20, v22
    v_mul_f32 v23, v20, v23
    v_mul_f32 v24, v126, v22
    v_fma_f32 v24, -v127, v23, v24
    v_mul_f32 v25, v126, v23
    v_fma_f32 v25, v127, v22, v25
    v_xor_b32 v25, 0x80000000, v25
    v_cvt_pk_bf16_f32 v102, v24, v25
    v_lshlrev_b32 v26, 16, v102
    v_and_b32 v27, 0xffff0000, v102
    v_sub_f32 v24, v24, v26
    v_sub_f32 v25, v25, v27
    v_cvt_pk_bf16_f32 v106, v24, v25
    v_mul_f32 v16, v128, v11
    v_mul_f32 v17, v129, v11
    v_exp_f32 v16, v16
    v_fract_f32 v17, v17
    v_mul_f32 v20, v128, v12
    v_mul_f32 v21, v129, v12
    v_cos_f32 v18, v17
    v_sin_f32 v19, v17
    v_exp_f32 v20, v20
    v_fract_f32 v21, v21
    v_mul_f32 v18, v16, v18
    v_mul_f32 v19, v16, v19
    v_cos_f32 v22, v21
    v_sin_f32 v23, v21
    v_cvt_pk_bf16_f32 v111, v18, v19
    v_lshlrev_b32 v24, 16, v111
    v_and_b32 v25, 0xffff0000, v111
    v_sub_f32 v18, v18, v24
    v_sub_f32 v19, v19, v25
    v_cvt_pk_bf16_f32 v115, v18, v19
    v_mul_f32 v22, v20, v22
    v_mul_f32 v23, v20, v23
    v_mul_f32 v24, v130, v22
    v_fma_f32 v24, -v131, v23, v24
    v_mul_f32 v25, v130, v23
    v_fma_f32 v25, v131, v22, v25
    v_xor_b32 v25, 0x80000000, v25
    v_cvt_pk_bf16_f32 v103, v24, v25
    v_lshlrev_b32 v26, 16, v103
    v_and_b32 v27, 0xffff0000, v103
    v_sub_f32 v24, v24, v26
    v_sub_f32 v25, v25, v27
    v_cvt_pk_bf16_f32 v107, v24, v25
    s_nop 1
    v_mfma_f32_32x32x16_bf16 v[68:83], v[100:103], v[108:111], v[68:83]
    v_mfma_f32_32x32x16_bf16 v[68:83], v[100:103], v[112:115], v[68:83]
    v_mfma_f32_32x32x16_bf16 v[68:83], v[104:107], v[108:111], v[68:83]
    ds_read_b128 v[116:119], v14 offset:128
    ds_read_b128 v[120:123], v14 offset:144
    ds_read_b128 v[124:127], v14 offset:160
    ds_read_b128 v[128:131], v14 offset:176
    s_waitcnt lgkmcnt(0)
    v_mul_f32 v16, v116, v11
    v_mul_f32 v17, v117, v11
    v_exp_f32 v16, v16
    v_fract_f32 v17, v17
    v_mul_f32 v20, v116, v12
    v_mul_f32 v21, v117, v12
    v_cos_f32 v18, v17
    v_sin_f32 v19, v17
    v_exp_f32 v20, v20
    v_fract_f32 v21, v21
    v_mul_f32 v18, v16, v18
    v_mul_f32 v19, v16, v19
    v_cos_f32 v22, v21
    v_sin_f32 v23, v21
    v_cvt_pk_bf16_f32 v108, v18, v19
    v_lshlrev_b32 v24, 16, v108
    v_and_b32 v25, 0xffff0000, v108
    v_sub_f32 v18, v18, v24
    v_sub_f32 v19, v19, v25
    v_cvt_pk_bf16_f32 v112, v18, v19
    v_mul_f32 v22, v20, v22
    v_mul_f32 v23, v20, v23
    v_mul_f32 v24, v118, v22
    v_fma_f32 v24, -v119, v23, v24
    v_mul_f32 v25, v118, v23
    v_fma_f32 v25, v119, v22, v25
    v_xor_b32 v25, 0x80000000, v25
    v_cvt_pk_bf16_f32 v100, v24, v25
    v_lshlrev_b32 v26, 16, v100
    v_and_b32 v27, 0xffff0000, v100
    v_sub_f32 v24, v24, v26
    v_sub_f32 v25, v25, v27
    v_cvt_pk_bf16_f32 v104, v24, v25
    v_mul_f32 v16, v120, v11
    v_mul_f32 v17, v121, v11
    v_exp_f32 v16, v16
    v_fract_f32 v17, v17
    v_mul_f32 v20, v120, v12
    v_mul_f32 v21, v121, v12
    v_cos_f32 v18, v17
    v_sin_f32 v19, v17
    v_exp_f32 v20, v20
    v_fract_f32 v21, v21
    v_mul_f32 v18, v16, v18
    v_mul_f32 v19, v16, v19
    v_cos_f32 v22, v21
    v_sin_f32 v23, v21
    v_cvt_pk_bf16_f32 v109, v18, v19
    v_lshlrev_b32 v24, 16, v109
    v_and_b32 v25, 0xffff0000, v109
    v_sub_f32 v18, v18, v24
    v_sub_f32 v19, v19, v25
    v_cvt_pk_bf16_f32 v113, v18, v19
    v_mul_f32 v22, v20, v22
    v_mul_f32 v23, v20, v23
    v_mul_f32 v24, v122, v22
    v_fma_f32 v24, -v123, v23, v24
    v_mul_f32 v25, v122, v23
    v_fma_f32 v25, v123, v22, v25
    v_xor_b32 v25, 0x80000000, v25
    v_cvt_pk_bf16_f32 v101, v24, v25
    v_lshlrev_b32 v26, 16, v101
    v_and_b32 v27, 0xffff0000, v101
    v_sub_f32 v24, v24, v26
    v_sub_f32 v25, v25, v27
    v_cvt_pk_bf16_f32 v105, v24, v25
    v_mul_f32 v16, v124, v11
    v_mul_f32 v17, v125, v11
    v_exp_f32 v16, v16
    v_fract_f32 v17, v17
    v_mul_f32 v20, v124, v12
    v_mul_f32 v21, v125, v12
    v_cos_f32 v18, v17
    v_sin_f32 v19, v17
    v_exp_f32 v20, v20
    v_fract_f32 v21, v21
    v_mul_f32 v18, v16, v18
    v_mul_f32 v19, v16, v19
    v_cos_f32 v22, v21
    v_sin_f32 v23, v21
    v_cvt_pk_bf16_f32 v110, v18, v19
    v_lshlrev_b32 v24, 16, v110
    v_and_b32 v25, 0xffff0000, v110
    v_sub_f32 v18, v18, v24
    v_sub_f32 v19, v19, v25
    v_cvt_pk_bf16_f32 v114, v18, v19
    v_mul_f32 v22, v20, v22
    v_mul_f32 v23, v20, v23
    v_mul_f32 v24, v126, v22
    v_fma_f32 v24, -v127, v23, v24
    v_mul_f32 v25, v126, v23
    v_fma_f32 v25, v127, v22, v25
    v_xor_b32 v25, 0x80000000, v25
    v_cvt_pk_bf16_f32 v102, v24, v25
    v_lshlrev_b32 v26, 16, v102
    v_and_b32 v27, 0xffff0000, v102
    v_sub_f32 v24, v24, v26
    v_sub_f32 v25, v25, v27
    v_cvt_pk_bf16_f32 v106, v24, v25
    v_mul_f32 v16, v128, v11
    v_mul_f32 v17, v129, v11
    v_exp_f32 v16, v16
    v_fract_f32 v17, v17
    v_mul_f32 v20, v128, v12
    v_mul_f32 v21, v129, v12
    v_cos_f32 v18, v17
    v_sin_f32 v19, v17
    v_exp_f32 v20, v20
    v_fract_f32 v21, v21
    v_mul_f32 v18, v16, v18
    v_mul_f32 v19, v16, v19
    v_cos_f32 v22, v21
    v_sin_f32 v23, v21
    v_cvt_pk_bf16_f32 v111, v18, v19
    v_lshlrev_b32 v24, 16, v111
    v_and_b32 v25, 0xffff0000, v111
    v_sub_f32 v18, v18, v24
    v_sub_f32 v19, v19, v25
    v_cvt_pk_bf16_f32 v115, v18, v19
    v_mul_f32 v22, v20, v22
    v_mul_f32 v23, v20, v23
    v_mul_f32 v24, v130, v22
    v_fma_f32 v24, -v131, v23, v24
    v_mul_f32 v25, v130, v23
    v_fma_f32 v25, v131, v22, v25
    v_xor_b32 v25, 0x80000000, v25
    v_cvt_pk_bf16_f32 v103, v24, v25
    v_lshlrev_b32 v26, 16, v103
    v_and_b32 v27, 0xffff0000, v103
    v_sub_f32 v24, v24, v26
    v_sub_f32 v25, v25, v27
    v_cvt_pk_bf16_f32 v107, v24, v25
    s_nop 1
    v_mfma_f32_32x32x16_bf16 v[68:83], v[100:103], v[108:111], v[68:83]
    v_mfma_f32_32x32x16_bf16 v[68:83], v[100:103], v[112:115], v[68:83]
    v_mfma_f32_32x32x16_bf16 v[68:83], v[104:107], v[108:111], v[68:83]
    ds_read_b128 v[116:119], v14 offset:192
    ds_read_b128 v[120:123], v14 offset:208
    ds_read_b128 v[124:127], v14 offset:224
    ds_read_b128 v[128:131], v14 offset:240
    s_waitcnt lgkmcnt(0)
    v_mul_f32 v16, v116, v11
    v_mul_f32 v17, v117, v11
    v_exp_f32 v16, v16
    v_fract_f32 v17, v17
    v_mul_f32 v20, v116, v12
    v_mul_f32 v21, v117, v12
    v_cos_f32 v18, v17
    v_sin_f32 v19, v17
    v_exp_f32 v20, v20
    v_fract_f32 v21, v21
    v_mul_f32 v18, v16, v18
    v_mul_f32 v19, v16, v19
    v_cos_f32 v22, v21
    v_sin_f32 v23, v21
    v_cvt_pk_bf16_f32 v108, v18, v19
    v_lshlrev_b32 v24, 16, v108
    v_and_b32 v25, 0xffff0000, v108
    v_sub_f32 v18, v18, v24
    v_sub_f32 v19, v19, v25
    v_cvt_pk_bf16_f32 v112, v18, v19
    v_mul_f32 v22, v20, v22
    v_mul_f32 v23, v20, v23
    v_mul_f32 v24, v118, v22
    v_fma_f32 v24, -v119, v23, v24
    v_mul_f32 v25, v118, v23
    v_fma_f32 v25, v119, v22, v25
    v_xor_b32 v25, 0x80000000, v25
    v_cvt_pk_bf16_f32 v100, v24, v25
    v_lshlrev_b32 v26, 16, v100
    v_and_b32 v27, 0xffff0000, v100
    v_sub_f32 v24, v24, v26
    v_sub_f32 v25, v25, v27
    v_cvt_pk_bf16_f32 v104, v24, v25
    v_mul_f32 v16, v120, v11
    v_mul_f32 v17, v121, v11
    v_exp_f32 v16, v16
    v_fract_f32 v17, v17
    v_mul_f32 v20, v120, v12
    v_mul_f32 v21, v121, v12
    v_cos_f32 v18, v17
    v_sin_f32 v19, v17
    v_exp_f32 v20, v20
    v_fract_f32 v21, v21
    v_mul_f32 v18, v16, v18
    v_mul_f32 v19, v16, v19
    v_cos_f32 v22, v21
    v_sin_f32 v23, v21
    v_cvt_pk_bf16_f32 v109, v18, v19
    v_lshlrev_b32 v24, 16, v109
    v_and_b32 v25, 0xffff0000, v109
    v_sub_f32 v18, v18, v24
    v_sub_f32 v19, v19, v25
    v_cvt_pk_bf16_f32 v113, v18, v19
    v_mul_f32 v22, v20, v22
    v_mul_f32 v23, v20, v23
    v_mul_f32 v24, v122, v22
    v_fma_f32 v24, -v123, v23, v24
    v_mul_f32 v25, v122, v23
    v_fma_f32 v25, v123, v22, v25
    v_xor_b32 v25, 0x80000000, v25
    v_cvt_pk_bf16_f32 v101, v24, v25
    v_lshlrev_b32 v26, 16, v101
    v_and_b32 v27, 0xffff0000, v101
    v_sub_f32 v24, v24, v26
    v_sub_f32 v25, v25, v27
    v_cvt_pk_bf16_f32 v105, v24, v25
    v_mul_f32 v16, v124, v11
    v_mul_f32 v17, v125, v11
    v_exp_f32 v16, v16
    v_fract_f32 v17, v17
    v_mul_f32 v20, v124, v12
    v_mul_f32 v21, v125, v12
    v_cos_f32 v18, v17
    v_sin_f32 v19, v17
    v_exp_f32 v20, v20
    v_fract_f32 v21, v21
    v_mul_f32 v18, v16, v18
    v_mul_f32 v19, v16, v19
    v_cos_f32 v22, v21
    v_sin_f32 v23, v21
    v_cvt_pk_bf16_f32 v110, v18, v19
    v_lshlrev_b32 v24, 16, v110
    v_and_b32 v25, 0xffff0000, v110
    v_sub_f32 v18, v18, v24
    v_sub_f32 v19, v19, v25
    v_cvt_pk_bf16_f32 v114, v18, v19
    v_mul_f32 v22, v20, v22
    v_mul_f32 v23, v20, v23
    v_mul_f32 v24, v126, v22
    v_fma_f32 v24, -v127, v23, v24
    v_mul_f32 v25, v126, v23
    v_fma_f32 v25, v127, v22, v25
    v_xor_b32 v25, 0x80000000, v25
    v_cvt_pk_bf16_f32 v102, v24, v25
    v_lshlrev_b32 v26, 16, v102
    v_and_b32 v27, 0xffff0000, v102
    v_sub_f32 v24, v24, v26
    v_sub_f32 v25, v25, v27
    v_cvt_pk_bf16_f32 v106, v24, v25
    v_mul_f32 v16, v128, v11
    v_mul_f32 v17, v129, v11
    v_exp_f32 v16, v16
    v_fract_f32 v17, v17
    v_mul_f32 v20, v128, v12
    v_mul_f32 v21, v129, v12
    v_cos_f32 v18, v17
    v_sin_f32 v19, v17
    v_exp_f32 v20, v20
    v_fract_f32 v21, v21
    v_mul_f32 v18, v16, v18
    v_mul_f32 v19, v16, v19
    v_cos_f32 v22, v21
    v_sin_f32 v23, v21
    v_cvt_pk_bf16_f32 v111, v18, v19
    v_lshlrev_b32 v24, 16, v111
    v_and_b32 v25, 0xffff0000, v111
    v_sub_f32 v18, v18, v24
    v_sub_f32 v19, v19, v25
    v_cvt_pk_bf16_f32 v115, v18, v19
    v_mul_f32 v22, v20, v22
    v_mul_f32 v23, v20, v23
    v_mul_f32 v24, v130, v22
    v_fma_f32 v24, -v131, v23, v24
    v_mul_f32 v25, v130, v23
    v_fma_f32 v25, v131, v22, v25
    v_xor_b32 v25, 0x80000000, v25
    v_cvt_pk_bf16_f32 v103, v24, v25
    v_lshlrev_b32 v26, 16, v103
    v_and_b32 v27, 0xffff0000, v103
    v_sub_f32 v24, v24, v26
    v_sub_f32 v25, v25, v27
    v_cvt_pk_bf16_f32 v107, v24, v25
    s_nop 1
    v_mfma_f32_32x32x16_bf16 v[68:83], v[100:103], v[108:111], v[68:83]
    v_mfma_f32_32x32x16_bf16 v[68:83], v[100:103], v[112:115], v[68:83]
    v_mfma_f32_32x32x16_bf16 v[68:83], v[104:107], v[108:111], v[68:83]
    ds_read_b128 v[116:119], v14 offset:256
    ds_read_b128 v[120:123], v14 offset:272
    ds_read_b128 v[124:127], v14 offset:288
    ds_read_b128 v[128:131], v14 offset:304
    s_waitcnt lgkmcnt(0)
    v_mul_f32 v16, v116, v11
    v_mul_f32 v17, v117, v11
    v_exp_f32 v16, v16
    v_fract_f32 v17, v17
    v_mul_f32 v20, v116, v12
    v_mul_f32 v21, v117, v12
    v_cos_f32 v18, v17
    v_sin_f32 v19, v17
    v_exp_f32 v20, v20
    v_fract_f32 v21, v21
    v_mul_f32 v18, v16, v18
    v_mul_f32 v19, v16, v19
    v_cos_f32 v22, v21
    v_sin_f32 v23, v21
    v_cvt_pk_bf16_f32 v108, v18, v19
    v_lshlrev_b32 v24, 16, v108
    v_and_b32 v25, 0xffff0000, v108
    v_sub_f32 v18, v18, v24
    v_sub_f32 v19, v19, v25
    v_cvt_pk_bf16_f32 v112, v18, v19
    v_mul_f32 v22, v20, v22
    v_mul_f32 v23, v20, v23
    v_mul_f32 v24, v118, v22
    v_fma_f32 v24, -v119, v23, v24
    v_mul_f32 v25, v118, v23
    v_fma_f32 v25, v119, v22, v25
    v_xor_b32 v25, 0x80000000, v25
    v_cvt_pk_bf16_f32 v100, v24, v25
    v_lshlrev_b32 v26, 16, v100
    v_and_b32 v27, 0xffff0000, v100
    v_sub_f32 v24, v24, v26
    v_sub_f32 v25, v25, v27
    v_cvt_pk_bf16_f32 v104, v24, v25
    v_mul_f32 v16, v120, v11
    v_mul_f32 v17, v121, v11
    v_exp_f32 v16, v16
    v_fract_f32 v17, v17
    v_mul_f32 v20, v120, v12
    v_mul_f32 v21, v121, v12
    v_cos_f32 v18, v17
    v_sin_f32 v19, v17
    v_exp_f32 v20, v20
    v_fract_f32 v21, v21
    v_mul_f32 v18, v16, v18
    v_mul_f32 v19, v16, v19
    v_cos_f32 v22, v21
    v_sin_f32 v23, v21
    v_cvt_pk_bf16_f32 v109, v18, v19
    v_lshlrev_b32 v24, 16, v109
    v_and_b32 v25, 0xffff0000, v109
    v_sub_f32 v18, v18, v24
    v_sub_f32 v19, v19, v25
    v_cvt_pk_bf16_f32 v113, v18, v19
    v_mul_f32 v22, v20, v22
    v_mul_f32 v23, v20, v23
    v_mul_f32 v24, v122, v22
    v_fma_f32 v24, -v123, v23, v24
    v_mul_f32 v25, v122, v23
    v_fma_f32 v25, v123, v22, v25
    v_xor_b32 v25, 0x80000000, v25
    v_cvt_pk_bf16_f32 v101, v24, v25
    v_lshlrev_b32 v26, 16, v101
    v_and_b32 v27, 0xffff0000, v101
    v_sub_f32 v24, v24, v26
    v_sub_f32 v25, v25, v27
    v_cvt_pk_bf16_f32 v105, v24, v25
    v_mul_f32 v16, v124, v11
    v_mul_f32 v17, v125, v11
    v_exp_f32 v16, v16
    v_fract_f32 v17, v17
    v_mul_f32 v20, v124, v12
    v_mul_f32 v21, v125, v12
    v_cos_f32 v18, v17
    v_sin_f32 v19, v17
    v_exp_f32 v20, v20
    v_fract_f32 v21, v21
    v_mul_f32 v18, v16, v18
    v_mul_f32 v19, v16, v19
    v_cos_f32 v22, v21
    v_sin_f32 v23, v21
    v_cvt_pk_bf16_f32 v110, v18, v19
    v_lshlrev_b32 v24, 16, v110
    v_and_b32 v25, 0xffff0000, v110
    v_sub_f32 v18, v18, v24
    v_sub_f32 v19, v19, v25
    v_cvt_pk_bf16_f32 v114, v18, v19
    v_mul_f32 v22, v20, v22
    v_mul_f32 v23, v20, v23
    v_mul_f32 v24, v126, v22
    v_fma_f32 v24, -v127, v23, v24
    v_mul_f32 v25, v126, v23
    v_fma_f32 v25, v127, v22, v25
    v_xor_b32 v25, 0x80000000, v25
    v_cvt_pk_bf16_f32 v102, v24, v25
    v_lshlrev_b32 v26, 16, v102
    v_and_b32 v27, 0xffff0000, v102
    v_sub_f32 v24, v24, v26
    v_sub_f32 v25, v25, v27
    v_cvt_pk_bf16_f32 v106, v24, v25
    v_mul_f32 v16, v128, v11
    v_mul_f32 v17, v129, v11
    v_exp_f32 v16, v16
    v_fract_f32 v17, v17
    v_mul_f32 v20, v128, v12
    v_mul_f32 v21, v129, v12
    v_cos_f32 v18, v17
    v_sin_f32 v19, v17
    v_exp_f32 v20, v20
    v_fract_f32 v21, v21
    v_mul_f32 v18, v16, v18
    v_mul_f32 v19, v16, v19
    v_cos_f32 v22, v21
    v_sin_f32 v23, v21
    v_cvt_pk_bf16_f32 v111, v18, v19
    v_lshlrev_b32 v24, 16, v111
    v_and_b32 v25, 0xffff0000, v111
    v_sub_f32 v18, v18, v24
    v_sub_f32 v19, v19, v25
    v_cvt_pk_bf16_f32 v115, v18, v19
    v_mul_f32 v22, v20, v22
    v_mul_f32 v23, v20, v23
    v_mul_f32 v24, v130, v22
    v_fma_f32 v24, -v131, v23, v24
    v_mul_f32 v25, v130, v23
    v_fma_f32 v25, v131, v22, v25
    v_xor_b32 v25, 0x80000000, v25
    v_cvt_pk_bf16_f32 v103, v24, v25
    v_lshlrev_b32 v26, 16, v103
    v_and_b32 v27, 0xffff0000, v103
    v_sub_f32 v24, v24, v26
    v_sub_f32 v25, v25, v27
    v_cvt_pk_bf16_f32 v107, v24, v25
    s_nop 1
    v_mfma_f32_32x32x16_bf16 v[68:83], v[100:103], v[108:111], v[68:83]
    v_mfma_f32_32x32x16_bf16 v[68:83], v[100:103], v[112:115], v[68:83]
    v_mfma_f32_32x32x16_bf16 v[68:83], v[104:107], v[108:111], v[68:83]
    ds_read_b128 v[116:119], v14 offset:320
    ds_read_b128 v[120:123], v14 offset:336
    ds_read_b128 v[124:127], v14 offset:352
    ds_read_b128 v[128:131], v14 offset:368
    s_waitcnt lgkmcnt(0)
    v_mul_f32 v16, v116, v11
    v_mul_f32 v17, v117, v11
    v_exp_f32 v16, v16
    v_fract_f32 v17, v17
    v_mul_f32 v20, v116, v12
    v_mul_f32 v21, v117, v12
    v_cos_f32 v18, v17
    v_sin_f32 v19, v17
    v_exp_f32 v20, v20
    v_fract_f32 v21, v21
    v_mul_f32 v18, v16, v18
    v_mul_f32 v19, v16, v19
    v_cos_f32 v22, v21
    v_sin_f32 v23, v21
    v_cvt_pk_bf16_f32 v108, v18, v19
    v_lshlrev_b32 v24, 16, v108
    v_and_b32 v25, 0xffff0000, v108
    v_sub_f32 v18, v18, v24
    v_sub_f32 v19, v19, v25
    v_cvt_pk_bf16_f32 v112, v18, v19
    v_mul_f32 v22, v20, v22
    v_mul_f32 v23, v20, v23
    v_mul_f32 v24, v118, v22
    v_fma_f32 v24, -v119, v23, v24
    v_mul_f32 v25, v118, v23
    v_fma_f32 v25, v119, v22, v25
    v_xor_b32 v25, 0x80000000, v25
    v_cvt_pk_bf16_f32 v100, v24, v25
    v_lshlrev_b32 v26, 16, v100
    v_and_b32 v27, 0xffff0000, v100
    v_sub_f32 v24, v24, v26
    v_sub_f32 v25, v25, v27
    v_cvt_pk_bf16_f32 v104, v24, v25
    v_mul_f32 v16, v120, v11
    v_mul_f32 v17, v121, v11
    v_exp_f32 v16, v16
    v_fract_f32 v17, v17
    v_mul_f32 v20, v120, v12
    v_mul_f32 v21, v121, v12
    v_cos_f32 v18, v17
    v_sin_f32 v19, v17
    v_exp_f32 v20, v20
    v_fract_f32 v21, v21
    v_mul_f32 v18, v16, v18
    v_mul_f32 v19, v16, v19
    v_cos_f32 v22, v21
    v_sin_f32 v23, v21
    v_cvt_pk_bf16_f32 v109, v18, v19
    v_lshlrev_b32 v24, 16, v109
    v_and_b32 v25, 0xffff0000, v109
    v_sub_f32 v18, v18, v24
    v_sub_f32 v19, v19, v25
    v_cvt_pk_bf16_f32 v113, v18, v19
    v_mul_f32 v22, v20, v22
    v_mul_f32 v23, v20, v23
    v_mul_f32 v24, v122, v22
    v_fma_f32 v24, -v123, v23, v24
    v_mul_f32 v25, v122, v23
    v_fma_f32 v25, v123, v22, v25
    v_xor_b32 v25, 0x80000000, v25
    v_cvt_pk_bf16_f32 v101, v24, v25
    v_lshlrev_b32 v26, 16, v101
    v_and_b32 v27, 0xffff0000, v101
    v_sub_f32 v24, v24, v26
    v_sub_f32 v25, v25, v27
    v_cvt_pk_bf16_f32 v105, v24, v25
    v_mul_f32 v16, v124, v11
    v_mul_f32 v17, v125, v11
    v_exp_f32 v16, v16
    v_fract_f32 v17, v17
    v_mul_f32 v20, v124, v12
    v_mul_f32 v21, v125, v12
    v_cos_f32 v18, v17
    v_sin_f32 v19, v17
    v_exp_f32 v20, v20
    v_fract_f32 v21, v21
    v_mul_f32 v18, v16, v18
    v_mul_f32 v19, v16, v19
    v_cos_f32 v22, v21
    v_sin_f32 v23, v21
    v_cvt_pk_bf16_f32 v110, v18, v19
    v_lshlrev_b32 v24, 16, v110
    v_and_b32 v25, 0xffff0000, v110
    v_sub_f32 v18, v18, v24
    v_sub_f32 v19, v19, v25
    v_cvt_pk_bf16_f32 v114, v18, v19
    v_mul_f32 v22, v20, v22
    v_mul_f32 v23, v20, v23
    v_mul_f32 v24, v126, v22
    v_fma_f32 v24, -v127, v23, v24
    v_mul_f32 v25, v126, v23
    v_fma_f32 v25, v127, v22, v25
    v_xor_b32 v25, 0x80000000, v25
    v_cvt_pk_bf16_f32 v102, v24, v25
    v_lshlrev_b32 v26, 16, v102
    v_and_b32 v27, 0xffff0000, v102
    v_sub_f32 v24, v24, v26
    v_sub_f32 v25, v25, v27
    v_cvt_pk_bf16_f32 v106, v24, v25
    v_mul_f32 v16, v128, v11
    v_mul_f32 v17, v129, v11
    v_exp_f32 v16, v16
    v_fract_f32 v17, v17
    v_mul_f32 v20, v128, v12
    v_mul_f32 v21, v129, v12
    v_cos_f32 v18, v17
    v_sin_f32 v19, v17
    v_exp_f32 v20, v20
    v_fract_f32 v21, v21
    v_mul_f32 v18, v16, v18
    v_mul_f32 v19, v16, v19
    v_cos_f32 v22, v21
    v_sin_f32 v23, v21
    v_cvt_pk_bf16_f32 v111, v18, v19
    v_lshlrev_b32 v24, 16, v111
    v_and_b32 v25, 0xffff0000, v111
    v_sub_f32 v18, v18, v24
    v_sub_f32 v19, v19, v25
    v_cvt_pk_bf16_f32 v115, v18, v19
    v_mul_f32 v22, v20, v22
    v_mul_f32 v23, v20, v23
    v_mul_f32 v24, v130, v22
    v_fma_f32 v24, -v131, v23, v24
    v_mul_f32 v25, v130, v23
    v_fma_f32 v25, v131, v22, v25
    v_xor_b32 v25, 0x80000000, v25
    v_cvt_pk_bf16_f32 v103, v24, v25
    v_lshlrev_b32 v26, 16, v103
    v_and_b32 v27, 0xffff0000, v103
    v_sub_f32 v24, v24, v26
    v_sub_f32 v25, v25, v27
    v_cvt_pk_bf16_f32 v107, v24, v25
    s_nop 1
    v_mfma_f32_32x32x16_bf16 v[68:83], v[100:103], v[108:111], v[68:83]
    v_mfma_f32_32x32x16_bf16 v[68:83], v[100:103], v[112:115], v[68:83]
    v_mfma_f32_32x32x16_bf16 v[68:83], v[104:107], v[108:111], v[68:83]
    ds_read_b128 v[116:119], v14 offset:384
    ds_read_b128 v[120:123], v14 offset:400
    ds_read_b128 v[124:127], v14 offset:416
    ds_read_b128 v[128:131], v14 offset:432
    s_waitcnt lgkmcnt(0)
    v_mul_f32 v16, v116, v11
    v_mul_f32 v17, v117, v11
    v_exp_f32 v16, v16
    v_fract_f32 v17, v17
    v_mul_f32 v20, v116, v12
    v_mul_f32 v21, v117, v12
    v_cos_f32 v18, v17
    v_sin_f32 v19, v17
    v_exp_f32 v20, v20
    v_fract_f32 v21, v21
    v_mul_f32 v18, v16, v18
    v_mul_f32 v19, v16, v19
    v_cos_f32 v22, v21
    v_sin_f32 v23, v21
    v_cvt_pk_bf16_f32 v108, v18, v19
    v_lshlrev_b32 v24, 16, v108
    v_and_b32 v25, 0xffff0000, v108
    v_sub_f32 v18, v18, v24
    v_sub_f32 v19, v19, v25
    v_cvt_pk_bf16_f32 v112, v18, v19
    v_mul_f32 v22, v20, v22
    v_mul_f32 v23, v20, v23
    v_mul_f32 v24, v118, v22
    v_fma_f32 v24, -v119, v23, v24
    v_mul_f32 v25, v118, v23
    v_fma_f32 v25, v119, v22, v25
    v_xor_b32 v25, 0x80000000, v25
    v_cvt_pk_bf16_f32 v100, v24, v25
    v_lshlrev_b32 v26, 16, v100
    v_and_b32 v27, 0xffff0000, v100
    v_sub_f32 v24, v24, v26
    v_sub_f32 v25, v25, v27
    v_cvt_pk_bf16_f32 v104, v24, v25
    v_mul_f32 v16, v120, v11
    v_mul_f32 v17, v121, v11
    v_exp_f32 v16, v16
    v_fract_f32 v17, v17
    v_mul_f32 v20, v120, v12
    v_mul_f32 v21, v121, v12
    v_cos_f32 v18, v17
    v_sin_f32 v19, v17
    v_exp_f32 v20, v20
    v_fract_f32 v21, v21
    v_mul_f32 v18, v16, v18
    v_mul_f32 v19, v16, v19
    v_cos_f32 v22, v21
    v_sin_f32 v23, v21
    v_cvt_pk_bf16_f32 v109, v18, v19
    v_lshlrev_b32 v24, 16, v109
    v_and_b32 v25, 0xffff0000, v109
    v_sub_f32 v18, v18, v24
    v_sub_f32 v19, v19, v25
    v_cvt_pk_bf16_f32 v113, v18, v19
    v_mul_f32 v22, v20, v22
    v_mul_f32 v23, v20, v23
    v_mul_f32 v24, v122, v22
    v_fma_f32 v24, -v123, v23, v24
    v_mul_f32 v25, v122, v23
    v_fma_f32 v25, v123, v22, v25
    v_xor_b32 v25, 0x80000000, v25
    v_cvt_pk_bf16_f32 v101, v24, v25
    v_lshlrev_b32 v26, 16, v101
    v_and_b32 v27, 0xffff0000, v101
    v_sub_f32 v24, v24, v26
    v_sub_f32 v25, v25, v27
    v_cvt_pk_bf16_f32 v105, v24, v25
    v_mul_f32 v16, v124, v11
    v_mul_f32 v17, v125, v11
    v_exp_f32 v16, v16
    v_fract_f32 v17, v17
    v_mul_f32 v20, v124, v12
    v_mul_f32 v21, v125, v12
    v_cos_f32 v18, v17
    v_sin_f32 v19, v17
    v_exp_f32 v20, v20
    v_fract_f32 v21, v21
    v_mul_f32 v18, v16, v18
    v_mul_f32 v19, v16, v19
    v_cos_f32 v22, v21
    v_sin_f32 v23, v21
    v_cvt_pk_bf16_f32 v110, v18, v19
    v_lshlrev_b32 v24, 16, v110
    v_and_b32 v25, 0xffff0000, v110
    v_sub_f32 v18, v18, v24
    v_sub_f32 v19, v19, v25
    v_cvt_pk_bf16_f32 v114, v18, v19
    v_mul_f32 v22, v20, v22
    v_mul_f32 v23, v20, v23
    v_mul_f32 v24, v126, v22
    v_fma_f32 v24, -v127, v23, v24
    v_mul_f32 v25, v126, v23
    v_fma_f32 v25, v127, v22, v25
    v_xor_b32 v25, 0x80000000, v25
    v_cvt_pk_bf16_f32 v102, v24, v25
    v_lshlrev_b32 v26, 16, v102
    v_and_b32 v27, 0xffff0000, v102
    v_sub_f32 v24, v24, v26
    v_sub_f32 v25, v25, v27
    v_cvt_pk_bf16_f32 v106, v24, v25
    v_mul_f32 v16, v128, v11
    v_mul_f32 v17, v129, v11
    v_exp_f32 v16, v16
    v_fract_f32 v17, v17
    v_mul_f32 v20, v128, v12
    v_mul_f32 v21, v129, v12
    v_cos_f32 v18, v17
    v_sin_f32 v19, v17
    v_exp_f32 v20, v20
    v_fract_f32 v21, v21
    v_mul_f32 v18, v16, v18
    v_mul_f32 v19, v16, v19
    v_cos_f32 v22, v21
    v_sin_f32 v23, v21
    v_cvt_pk_bf16_f32 v111, v18, v19
    v_lshlrev_b32 v24, 16, v111
    v_and_b32 v25, 0xffff0000, v111
    v_sub_f32 v18, v18, v24
    v_sub_f32 v19, v19, v25
    v_cvt_pk_bf16_f32 v115, v18, v19
    v_mul_f32 v22, v20, v22
    v_mul_f32 v23, v20, v23
    v_mul_f32 v24, v130, v22
    v_fma_f32 v24, -v131, v23, v24
    v_mul_f32 v25, v130, v23
    v_fma_f32 v25, v131, v22, v25
    v_xor_b32 v25, 0x80000000, v25
    v_cvt_pk_bf16_f32 v103, v24, v25
    v_lshlrev_b32 v26, 16, v103
    v_and_b32 v27, 0xffff0000, v103
    v_sub_f32 v24, v24, v26
    v_sub_f32 v25, v25, v27
    v_cvt_pk_bf16_f32 v107, v24, v25
    s_nop 1
    v_mfma_f32_32x32x16_bf16 v[68:83], v[100:103], v[108:111], v[68:83]
    v_mfma_f32_32x32x16_bf16 v[68:83], v[100:103], v[112:115], v[68:83]
    v_mfma_f32_32x32x16_bf16 v[68:83], v[104:107], v[108:111], v[68:83]
    ds_read_b128 v[116:119], v14 offset:448
    ds_read_b128 v[120:123], v14 offset:464
    ds_read_b128 v[124:127], v14 offset:480
    ds_read_b128 v[128:131], v14 offset:496
    s_waitcnt lgkmcnt(0)
    v_mul_f32 v16, v116, v11
    v_mul_f32 v17, v117, v11
    v_exp_f32 v16, v16
    v_fract_f32 v17, v17
    v_mul_f32 v20, v116, v12
    v_mul_f32 v21, v117, v12
    v_cos_f32 v18, v17
    v_sin_f32 v19, v17
    v_exp_f32 v20, v20
    v_fract_f32 v21, v21
    v_mul_f32 v18, v16, v18
    v_mul_f32 v19, v16, v19
    v_cos_f32 v22, v21
    v_sin_f32 v23, v21
    v_cvt_pk_bf16_f32 v108, v18, v19
    v_lshlrev_b32 v24, 16, v108
    v_and_b32 v25, 0xffff0000, v108
    v_sub_f32 v18, v18, v24
    v_sub_f32 v19, v19, v25
    v_cvt_pk_bf16_f32 v112, v18, v19
    v_mul_f32 v22, v20, v22
    v_mul_f32 v23, v20, v23
    v_mul_f32 v24, v118, v22
    v_fma_f32 v24, -v119, v23, v24
    v_mul_f32 v25, v118, v23
    v_fma_f32 v25, v119, v22, v25
    v_xor_b32 v25, 0x80000000, v25
    v_cvt_pk_bf16_f32 v100, v24, v25
    v_lshlrev_b32 v26, 16, v100
    v_and_b32 v27, 0xffff0000, v100
    v_sub_f32 v24, v24, v26
    v_sub_f32 v25, v25, v27
    v_cvt_pk_bf16_f32 v104, v24, v25
    v_mul_f32 v16, v120, v11
    v_mul_f32 v17, v121, v11
    v_exp_f32 v16, v16
    v_fract_f32 v17, v17
    v_mul_f32 v20, v120, v12
    v_mul_f32 v21, v121, v12
    v_cos_f32 v18, v17
    v_sin_f32 v19, v17
    v_exp_f32 v20, v20
    v_fract_f32 v21, v21
    v_mul_f32 v18, v16, v18
    v_mul_f32 v19, v16, v19
    v_cos_f32 v22, v21
    v_sin_f32 v23, v21
    v_cvt_pk_bf16_f32 v109, v18, v19
    v_lshlrev_b32 v24, 16, v109
    v_and_b32 v25, 0xffff0000, v109
    v_sub_f32 v18, v18, v24
    v_sub_f32 v19, v19, v25
    v_cvt_pk_bf16_f32 v113, v18, v19
    v_mul_f32 v22, v20, v22
    v_mul_f32 v23, v20, v23
    v_mul_f32 v24, v122, v22
    v_fma_f32 v24, -v123, v23, v24
    v_mul_f32 v25, v122, v23
    v_fma_f32 v25, v123, v22, v25
    v_xor_b32 v25, 0x80000000, v25
    v_cvt_pk_bf16_f32 v101, v24, v25
    v_lshlrev_b32 v26, 16, v101
    v_and_b32 v27, 0xffff0000, v101
    v_sub_f32 v24, v24, v26
    v_sub_f32 v25, v25, v27
    v_cvt_pk_bf16_f32 v105, v24, v25
    v_mul_f32 v16, v124, v11
    v_mul_f32 v17, v125, v11
    v_exp_f32 v16, v16
    v_fract_f32 v17, v17
    v_mul_f32 v20, v124, v12
    v_mul_f32 v21, v125, v12
    v_cos_f32 v18, v17
    v_sin_f32 v19, v17
    v_exp_f32 v20, v20
    v_fract_f32 v21, v21
    v_mul_f32 v18, v16, v18
    v_mul_f32 v19, v16, v19
    v_cos_f32 v22, v21
    v_sin_f32 v23, v21
    v_cvt_pk_bf16_f32 v110, v18, v19
    v_lshlrev_b32 v24, 16, v110
    v_and_b32 v25, 0xffff0000, v110
    v_sub_f32 v18, v18, v24
    v_sub_f32 v19, v19, v25
    v_cvt_pk_bf16_f32 v114, v18, v19
    v_mul_f32 v22, v20, v22
    v_mul_f32 v23, v20, v23
    v_mul_f32 v24, v126, v22
    v_fma_f32 v24, -v127, v23, v24
    v_mul_f32 v25, v126, v23
    v_fma_f32 v25, v127, v22, v25
    v_xor_b32 v25, 0x80000000, v25
    v_cvt_pk_bf16_f32 v102, v24, v25
    v_lshlrev_b32 v26, 16, v102
    v_and_b32 v27, 0xffff0000, v102
    v_sub_f32 v24, v24, v26
    v_sub_f32 v25, v25, v27
    v_cvt_pk_bf16_f32 v106, v24, v25
    v_mul_f32 v16, v128, v11
    v_mul_f32 v17, v129, v11
    v_exp_f32 v16, v16
    v_fract_f32 v17, v17
    v_mul_f32 v20, v128, v12
    v_mul_f32 v21, v129, v12
    v_cos_f32 v18, v17
    v_sin_f32 v19, v17
    v_exp_f32 v20, v20
    v_fract_f32 v21, v21
    v_mul_f32 v18, v16, v18
    v_mul_f32 v19, v16, v19
    v_cos_f32 v22, v21
    v_sin_f32 v23, v21
    v_cvt_pk_bf16_f32 v111, v18, v19
    v_lshlrev_b32 v24, 16, v111
    v_and_b32 v25, 0xffff0000, v111
    v_sub_f32 v18, v18, v24
    v_sub_f32 v19, v19, v25
    v_cvt_pk_bf16_f32 v115, v18, v19
    v_mul_f32 v22, v20, v22
    v_mul_f32 v23, v20, v23
    v_mul_f32 v24, v130, v22
    v_fma_f32 v24, -v131, v23, v24
    v_mul_f32 v25, v130, v23
    v_fma_f32 v25, v131, v22, v25
    v_xor_b32 v25, 0x80000000, v25
    v_cvt_pk_bf16_f32 v103, v24, v25
    v_lshlrev_b32 v26, 16, v103
    v_and_b32 v27, 0xffff0000, v103
    v_sub_f32 v24, v24, v26
    v_sub_f32 v25, v25, v27
    v_cvt_pk_bf16_f32 v107, v24, v25
    s_nop 1
    v_mfma_f32_32x32x16_bf16 v[68:83], v[100:103], v[108:111], v[68:83]
    v_mfma_f32_32x32x16_bf16 v[68:83], v[100:103], v[112:115], v[68:83]
    v_mfma_f32_32x32x16_bf16 v[68:83], v[104:107], v[108:111], v[68:83]
    ds_read_b128 v[116:119], v14 offset:512
    ds_read_b128 v[120:123], v14 offset:528
    ds_read_b128 v[124:127], v14 offset:544
    ds_read_b128 v[128:131], v14 offset:560
    s_waitcnt lgkmcnt(0)
    v_mul_f32 v16, v116, v11
    v_mul_f32 v17, v117, v11
    v_exp_f32 v16, v16
    v_fract_f32 v17, v17
    v_mul_f32 v20, v116, v12
    v_mul_f32 v21, v117, v12
    v_cos_f32 v18, v17
    v_sin_f32 v19, v17
    v_exp_f32 v20, v20
    v_fract_f32 v21, v21
    v_mul_f32 v18, v16, v18
    v_mul_f32 v19, v16, v19
    v_cos_f32 v22, v21
    v_sin_f32 v23, v21
    v_cvt_pk_bf16_f32 v108, v18, v19
    v_lshlrev_b32 v24, 16, v108
    v_and_b32 v25, 0xffff0000, v108
    v_sub_f32 v18, v18, v24
    v_sub_f32 v19, v19, v25
    v_cvt_pk_bf16_f32 v112, v18, v19
    v_mul_f32 v22, v20, v22
    v_mul_f32 v23, v20, v23
    v_mul_f32 v24, v118, v22
    v_fma_f32 v24, -v119, v23, v24
    v_mul_f32 v25, v118, v23
    v_fma_f32 v25, v119, v22, v25
    v_xor_b32 v25, 0x80000000, v25
    v_cvt_pk_bf16_f32 v100, v24, v25
    v_lshlrev_b32 v26, 16, v100
    v_and_b32 v27, 0xffff0000, v100
    v_sub_f32 v24, v24, v26
    v_sub_f32 v25, v25, v27
    v_cvt_pk_bf16_f32 v104, v24, v25
    v_mul_f32 v16, v120, v11
    v_mul_f32 v17, v121, v11
    v_exp_f32 v16, v16
    v_fract_f32 v17, v17
    v_mul_f32 v20, v120, v12
    v_mul_f32 v21, v121, v12
    v_cos_f32 v18, v17
    v_sin_f32 v19, v17
    v_exp_f32 v20, v20
    v_fract_f32 v21, v21
    v_mul_f32 v18, v16, v18
    v_mul_f32 v19, v16, v19
    v_cos_f32 v22, v21
    v_sin_f32 v23, v21
    v_cvt_pk_bf16_f32 v109, v18, v19
    v_lshlrev_b32 v24, 16, v109
    v_and_b32 v25, 0xffff0000, v109
    v_sub_f32 v18, v18, v24
    v_sub_f32 v19, v19, v25
    v_cvt_pk_bf16_f32 v113, v18, v19
    v_mul_f32 v22, v20, v22
    v_mul_f32 v23, v20, v23
    v_mul_f32 v24, v122, v22
    v_fma_f32 v24, -v123, v23, v24
    v_mul_f32 v25, v122, v23
    v_fma_f32 v25, v123, v22, v25
    v_xor_b32 v25, 0x80000000, v25
    v_cvt_pk_bf16_f32 v101, v24, v25
    v_lshlrev_b32 v26, 16, v101
    v_and_b32 v27, 0xffff0000, v101
    v_sub_f32 v24, v24, v26
    v_sub_f32 v25, v25, v27
    v_cvt_pk_bf16_f32 v105, v24, v25
    v_mul_f32 v16, v124, v11
    v_mul_f32 v17, v125, v11
    v_exp_f32 v16, v16
    v_fract_f32 v17, v17
    v_mul_f32 v20, v124, v12
    v_mul_f32 v21, v125, v12
    v_cos_f32 v18, v17
    v_sin_f32 v19, v17
    v_exp_f32 v20, v20
    v_fract_f32 v21, v21
    v_mul_f32 v18, v16, v18
    v_mul_f32 v19, v16, v19
    v_cos_f32 v22, v21
    v_sin_f32 v23, v21
    v_cvt_pk_bf16_f32 v110, v18, v19
    v_lshlrev_b32 v24, 16, v110
    v_and_b32 v25, 0xffff0000, v110
    v_sub_f32 v18, v18, v24
    v_sub_f32 v19, v19, v25
    v_cvt_pk_bf16_f32 v114, v18, v19
    v_mul_f32 v22, v20, v22
    v_mul_f32 v23, v20, v23
    v_mul_f32 v24, v126, v22
    v_fma_f32 v24, -v127, v23, v24
    v_mul_f32 v25, v126, v23
    v_fma_f32 v25, v127, v22, v25
    v_xor_b32 v25, 0x80000000, v25
    v_cvt_pk_bf16_f32 v102, v24, v25
    v_lshlrev_b32 v26, 16, v102
    v_and_b32 v27, 0xffff0000, v102
    v_sub_f32 v24, v24, v26
    v_sub_f32 v25, v25, v27
    v_cvt_pk_bf16_f32 v106, v24, v25
    v_mul_f32 v16, v128, v11
    v_mul_f32 v17, v129, v11
    v_exp_f32 v16, v16
    v_fract_f32 v17, v17
    v_mul_f32 v20, v128, v12
    v_mul_f32 v21, v129, v12
    v_cos_f32 v18, v17
    v_sin_f32 v19, v17
    v_exp_f32 v20, v20
    v_fract_f32 v21, v21
    v_mul_f32 v18, v16, v18
    v_mul_f32 v19, v16, v19
    v_cos_f32 v22, v21
    v_sin_f32 v23, v21
    v_cvt_pk_bf16_f32 v111, v18, v19
    v_lshlrev_b32 v24, 16, v111
    v_and_b32 v25, 0xffff0000, v111
    v_sub_f32 v18, v18, v24
    v_sub_f32 v19, v19, v25
    v_cvt_pk_bf16_f32 v115, v18, v19
    v_mul_f32 v22, v20, v22
    v_mul_f32 v23, v20, v23
    v_mul_f32 v24, v130, v22
    v_fma_f32 v24, -v131, v23, v24
    v_mul_f32 v25, v130, v23
    v_fma_f32 v25, v131, v22, v25
    v_xor_b32 v25, 0x80000000, v25
    v_cvt_pk_bf16_f32 v103, v24, v25
    v_lshlrev_b32 v26, 16, v103
    v_and_b32 v27, 0xffff0000, v103
    v_sub_f32 v24, v24, v26
    v_sub_f32 v25, v25, v27
    v_cvt_pk_bf16_f32 v107, v24, v25
    s_nop 1
    v_mfma_f32_32x32x16_bf16 v[68:83], v[100:103], v[108:111], v[68:83]
    v_mfma_f32_32x32x16_bf16 v[68:83], v[100:103], v[112:115], v[68:83]
    v_mfma_f32_32x32x16_bf16 v[68:83], v[104:107], v[108:111], v[68:83]
    ds_read_b128 v[116:119], v14 offset:576
    ds_read_b128 v[120:123], v14 offset:592
    ds_read_b128 v[124:127], v14 offset:608
    ds_read_b128 v[128:131], v14 offset:624
    s_waitcnt lgkmcnt(0)
    v_mul_f32 v16, v116, v11
    v_mul_f32 v17, v117, v11
    v_exp_f32 v16, v16
    v_fract_f32 v17, v17
    v_mul_f32 v20, v116, v12
    v_mul_f32 v21, v117, v12
    v_cos_f32 v18, v17
    v_sin_f32 v19, v17
    v_exp_f32 v20, v20
    v_fract_f32 v21, v21
    v_mul_f32 v18, v16, v18
    v_mul_f32 v19, v16, v19
    v_cos_f32 v22, v21
    v_sin_f32 v23, v21
    v_cvt_pk_bf16_f32 v108, v18, v19
    v_lshlrev_b32 v24, 16, v108
    v_and_b32 v25, 0xffff0000, v108
    v_sub_f32 v18, v18, v24
    v_sub_f32 v19, v19, v25
    v_cvt_pk_bf16_f32 v112, v18, v19
    v_mul_f32 v22, v20, v22
    v_mul_f32 v23, v20, v23
    v_mul_f32 v24, v118, v22
    v_fma_f32 v24, -v119, v23, v24
    v_mul_f32 v25, v118, v23
    v_fma_f32 v25, v119, v22, v25
    v_xor_b32 v25, 0x80000000, v25
    v_cvt_pk_bf16_f32 v100, v24, v25
    v_lshlrev_b32 v26, 16, v100
    v_and_b32 v27, 0xffff0000, v100
    v_sub_f32 v24, v24, v26
    v_sub_f32 v25, v25, v27
    v_cvt_pk_bf16_f32 v104, v24, v25
    v_mul_f32 v16, v120, v11
    v_mul_f32 v17, v121, v11
    v_exp_f32 v16, v16
    v_fract_f32 v17, v17
    v_mul_f32 v20, v120, v12
    v_mul_f32 v21, v121, v12
    v_cos_f32 v18, v17
    v_sin_f32 v19, v17
    v_exp_f32 v20, v20
    v_fract_f32 v21, v21
    v_mul_f32 v18, v16, v18
    v_mul_f32 v19, v16, v19
    v_cos_f32 v22, v21
    v_sin_f32 v23, v21
    v_cvt_pk_bf16_f32 v109, v18, v19
    v_lshlrev_b32 v24, 16, v109
    v_and_b32 v25, 0xffff0000, v109
    v_sub_f32 v18, v18, v24
    v_sub_f32 v19, v19, v25
    v_cvt_pk_bf16_f32 v113, v18, v19
    v_mul_f32 v22, v20, v22
    v_mul_f32 v23, v20, v23
    v_mul_f32 v24, v122, v22
    v_fma_f32 v24, -v123, v23, v24
    v_mul_f32 v25, v122, v23
    v_fma_f32 v25, v123, v22, v25
    v_xor_b32 v25, 0x80000000, v25
    v_cvt_pk_bf16_f32 v101, v24, v25
    v_lshlrev_b32 v26, 16, v101
    v_and_b32 v27, 0xffff0000, v101
    v_sub_f32 v24, v24, v26
    v_sub_f32 v25, v25, v27
    v_cvt_pk_bf16_f32 v105, v24, v25
    v_mul_f32 v16, v124, v11
    v_mul_f32 v17, v125, v11
    v_exp_f32 v16, v16
    v_fract_f32 v17, v17
    v_mul_f32 v20, v124, v12
    v_mul_f32 v21, v125, v12
    v_cos_f32 v18, v17
    v_sin_f32 v19, v17
    v_exp_f32 v20, v20
    v_fract_f32 v21, v21
    v_mul_f32 v18, v16, v18
    v_mul_f32 v19, v16, v19
    v_cos_f32 v22, v21
    v_sin_f32 v23, v21
    v_cvt_pk_bf16_f32 v110, v18, v19
    v_lshlrev_b32 v24, 16, v110
    v_and_b32 v25, 0xffff0000, v110
    v_sub_f32 v18, v18, v24
    v_sub_f32 v19, v19, v25
    v_cvt_pk_bf16_f32 v114, v18, v19
    v_mul_f32 v22, v20, v22
    v_mul_f32 v23, v20, v23
    v_mul_f32 v24, v126, v22
    v_fma_f32 v24, -v127, v23, v24
    v_mul_f32 v25, v126, v23
    v_fma_f32 v25, v127, v22, v25
    v_xor_b32 v25, 0x80000000, v25
    v_cvt_pk_bf16_f32 v102, v24, v25
    v_lshlrev_b32 v26, 16, v102
    v_and_b32 v27, 0xffff0000, v102
    v_sub_f32 v24, v24, v26
    v_sub_f32 v25, v25, v27
    v_cvt_pk_bf16_f32 v106, v24, v25
    v_mul_f32 v16, v128, v11
    v_mul_f32 v17, v129, v11
    v_exp_f32 v16, v16
    v_fract_f32 v17, v17
    v_mul_f32 v20, v128, v12
    v_mul_f32 v21, v129, v12
    v_cos_f32 v18, v17
    v_sin_f32 v19, v17
    v_exp_f32 v20, v20
    v_fract_f32 v21, v21
    v_mul_f32 v18, v16, v18
    v_mul_f32 v19, v16, v19
    v_cos_f32 v22, v21
    v_sin_f32 v23, v21
    v_cvt_pk_bf16_f32 v111, v18, v19
    v_lshlrev_b32 v24, 16, v111
    v_and_b32 v25, 0xffff0000, v111
    v_sub_f32 v18, v18, v24
    v_sub_f32 v19, v19, v25
    v_cvt_pk_bf16_f32 v115, v18, v19
    v_mul_f32 v22, v20, v22
    v_mul_f32 v23, v20, v23
    v_mul_f32 v24, v130, v22
    v_fma_f32 v24, -v131, v23, v24
    v_mul_f32 v25, v130, v23
    v_fma_f32 v25, v131, v22, v25
    v_xor_b32 v25, 0x80000000, v25
    v_cvt_pk_bf16_f32 v103, v24, v25
    v_lshlrev_b32 v26, 16, v103
    v_and_b32 v27, 0xffff0000, v103
    v_sub_f32 v24, v24, v26
    v_sub_f32 v25, v25, v27
    v_cvt_pk_bf16_f32 v107, v24, v25
    s_nop 1
    v_mfma_f32_32x32x16_bf16 v[68:83], v[100:103], v[108:111], v[68:83]
    v_mfma_f32_32x32x16_bf16 v[68:83], v[100:103], v[112:115], v[68:83]
    v_mfma_f32_32x32x16_bf16 v[68:83], v[104:107], v[108:111], v[68:83]
    ds_read_b128 v[116:119], v14 offset:640
    ds_read_b128 v[120:123], v14 offset:656
    ds_read_b128 v[124:127], v14 offset:672
    ds_read_b128 v[128:131], v14 offset:688
    s_waitcnt lgkmcnt(0)
    v_mul_f32 v16, v116, v11
    v_mul_f32 v17, v117, v11
    v_exp_f32 v16, v16
    v_fract_f32 v17, v17
    v_mul_f32 v20, v116, v12
    v_mul_f32 v21, v117, v12
    v_cos_f32 v18, v17
    v_sin_f32 v19, v17
    v_exp_f32 v20, v20
    v_fract_f32 v21, v21
    v_mul_f32 v18, v16, v18
    v_mul_f32 v19, v16, v19
    v_cos_f32 v22, v21
    v_sin_f32 v23, v21
    v_cvt_pk_bf16_f32 v108, v18, v19
    v_lshlrev_b32 v24, 16, v108
    v_and_b32 v25, 0xffff0000, v108
    v_sub_f32 v18, v18, v24
    v_sub_f32 v19, v19, v25
    v_cvt_pk_bf16_f32 v112, v18, v19
    v_mul_f32 v22, v20, v22
    v_mul_f32 v23, v20, v23
    v_mul_f32 v24, v118, v22
    v_fma_f32 v24, -v119, v23, v24
    v_mul_f32 v25, v118, v23
    v_fma_f32 v25, v119, v22, v25
    v_xor_b32 v25, 0x80000000, v25
    v_cvt_pk_bf16_f32 v100, v24, v25
    v_lshlrev_b32 v26, 16, v100
    v_and_b32 v27, 0xffff0000, v100
    v_sub_f32 v24, v24, v26
    v_sub_f32 v25, v25, v27
    v_cvt_pk_bf16_f32 v104, v24, v25
    v_mul_f32 v16, v120, v11
    v_mul_f32 v17, v121, v11
    v_exp_f32 v16, v16
    v_fract_f32 v17, v17
    v_mul_f32 v20, v120, v12
    v_mul_f32 v21, v121, v12
    v_cos_f32 v18, v17
    v_sin_f32 v19, v17
    v_exp_f32 v20, v20
    v_fract_f32 v21, v21
    v_mul_f32 v18, v16, v18
    v_mul_f32 v19, v16, v19
    v_cos_f32 v22, v21
    v_sin_f32 v23, v21
    v_cvt_pk_bf16_f32 v109, v18, v19
    v_lshlrev_b32 v24, 16, v109
    v_and_b32 v25, 0xffff0000, v109
    v_sub_f32 v18, v18, v24
    v_sub_f32 v19, v19, v25
    v_cvt_pk_bf16_f32 v113, v18, v19
    v_mul_f32 v22, v20, v22
    v_mul_f32 v23, v20, v23
    v_mul_f32 v24, v122, v22
    v_fma_f32 v24, -v123, v23, v24
    v_mul_f32 v25, v122, v23
    v_fma_f32 v25, v123, v22, v25
    v_xor_b32 v25, 0x80000000, v25
    v_cvt_pk_bf16_f32 v101, v24, v25
    v_lshlrev_b32 v26, 16, v101
    v_and_b32 v27, 0xffff0000, v101
    v_sub_f32 v24, v24, v26
    v_sub_f32 v25, v25, v27
    v_cvt_pk_bf16_f32 v105, v24, v25
    v_mul_f32 v16, v124, v11
    v_mul_f32 v17, v125, v11
    v_exp_f32 v16, v16
    v_fract_f32 v17, v17
    v_mul_f32 v20, v124, v12
    v_mul_f32 v21, v125, v12
    v_cos_f32 v18, v17
    v_sin_f32 v19, v17
    v_exp_f32 v20, v20
    v_fract_f32 v21, v21
    v_mul_f32 v18, v16, v18
    v_mul_f32 v19, v16, v19
    v_cos_f32 v22, v21
    v_sin_f32 v23, v21
    v_cvt_pk_bf16_f32 v110, v18, v19
    v_lshlrev_b32 v24, 16, v110
    v_and_b32 v25, 0xffff0000, v110
    v_sub_f32 v18, v18, v24
    v_sub_f32 v19, v19, v25
    v_cvt_pk_bf16_f32 v114, v18, v19
    v_mul_f32 v22, v20, v22
    v_mul_f32 v23, v20, v23
    v_mul_f32 v24, v126, v22
    v_fma_f32 v24, -v127, v23, v24
    v_mul_f32 v25, v126, v23
    v_fma_f32 v25, v127, v22, v25
    v_xor_b32 v25, 0x80000000, v25
    v_cvt_pk_bf16_f32 v102, v24, v25
    v_lshlrev_b32 v26, 16, v102
    v_and_b32 v27, 0xffff0000, v102
    v_sub_f32 v24, v24, v26
    v_sub_f32 v25, v25, v27
    v_cvt_pk_bf16_f32 v106, v24, v25
    v_mul_f32 v16, v128, v11
    v_mul_f32 v17, v129, v11
    v_exp_f32 v16, v16
    v_fract_f32 v17, v17
    v_mul_f32 v20, v128, v12
    v_mul_f32 v21, v129, v12
    v_cos_f32 v18, v17
    v_sin_f32 v19, v17
    v_exp_f32 v20, v20
    v_fract_f32 v21, v21
    v_mul_f32 v18, v16, v18
    v_mul_f32 v19, v16, v19
    v_cos_f32 v22, v21
    v_sin_f32 v23, v21
    v_cvt_pk_bf16_f32 v111, v18, v19
    v_lshlrev_b32 v24, 16, v111
    v_and_b32 v25, 0xffff0000, v111
    v_sub_f32 v18, v18, v24
    v_sub_f32 v19, v19, v25
    v_cvt_pk_bf16_f32 v115, v18, v19
    v_mul_f32 v22, v20, v22
    v_mul_f32 v23, v20, v23
    v_mul_f32 v24, v130, v22
    v_fma_f32 v24, -v131, v23, v24
    v_mul_f32 v25, v130, v23
    v_fma_f32 v25, v131, v22, v25
    v_xor_b32 v25, 0x80000000, v25
    v_cvt_pk_bf16_f32 v103, v24, v25
    v_lshlrev_b32 v26, 16, v103
    v_and_b32 v27, 0xffff0000, v103
    v_sub_f32 v24, v24, v26
    v_sub_f32 v25, v25, v27
    v_cvt_pk_bf16_f32 v107, v24, v25
    s_nop 1
    v_mfma_f32_32x32x16_bf16 v[68:83], v[100:103], v[108:111], v[68:83]
    v_mfma_f32_32x32x16_bf16 v[68:83], v[100:103], v[112:115], v[68:83]
    v_mfma_f32_32x32x16_bf16 v[68:83], v[104:107], v[108:111], v[68:83]
    ds_read_b128 v[116:119], v14 offset:704
    ds_read_b128 v[120:123], v14 offset:720
    ds_read_b128 v[124:127], v14 offset:736
    ds_read_b128 v[128:131], v14 offset:752
    s_waitcnt lgkmcnt(0)
    v_mul_f32 v16, v116, v11
    v_mul_f32 v17, v117, v11
    v_exp_f32 v16, v16
    v_fract_f32 v17, v17
    v_mul_f32 v20, v116, v12
    v_mul_f32 v21, v117, v12
    v_cos_f32 v18, v17
    v_sin_f32 v19, v17
    v_exp_f32 v20, v20
    v_fract_f32 v21, v21
    v_mul_f32 v18, v16, v18
    v_mul_f32 v19, v16, v19
    v_cos_f32 v22, v21
    v_sin_f32 v23, v21
    v_cvt_pk_bf16_f32 v108, v18, v19
    v_lshlrev_b32 v24, 16, v108
    v_and_b32 v25, 0xffff0000, v108
    v_sub_f32 v18, v18, v24
    v_sub_f32 v19, v19, v25
    v_cvt_pk_bf16_f32 v112, v18, v19
    v_mul_f32 v22, v20, v22
    v_mul_f32 v23, v20, v23
    v_mul_f32 v24, v118, v22
    v_fma_f32 v24, -v119, v23, v24
    v_mul_f32 v25, v118, v23
    v_fma_f32 v25, v119, v22, v25
    v_xor_b32 v25, 0x80000000, v25
    v_cvt_pk_bf16_f32 v100, v24, v25
    v_lshlrev_b32 v26, 16, v100
    v_and_b32 v27, 0xffff0000, v100
    v_sub_f32 v24, v24, v26
    v_sub_f32 v25, v25, v27
    v_cvt_pk_bf16_f32 v104, v24, v25
    v_mul_f32 v16, v120, v11
    v_mul_f32 v17, v121, v11
    v_exp_f32 v16, v16
    v_fract_f32 v17, v17
    v_mul_f32 v20, v120, v12
    v_mul_f32 v21, v121, v12
    v_cos_f32 v18, v17
    v_sin_f32 v19, v17
    v_exp_f32 v20, v20
    v_fract_f32 v21, v21
    v_mul_f32 v18, v16, v18
    v_mul_f32 v19, v16, v19
    v_cos_f32 v22, v21
    v_sin_f32 v23, v21
    v_cvt_pk_bf16_f32 v109, v18, v19
    v_lshlrev_b32 v24, 16, v109
    v_and_b32 v25, 0xffff0000, v109
    v_sub_f32 v18, v18, v24
    v_sub_f32 v19, v19, v25
    v_cvt_pk_bf16_f32 v113, v18, v19
    v_mul_f32 v22, v20, v22
    v_mul_f32 v23, v20, v23
    v_mul_f32 v24, v122, v22
    v_fma_f32 v24, -v123, v23, v24
    v_mul_f32 v25, v122, v23
    v_fma_f32 v25, v123, v22, v25
    v_xor_b32 v25, 0x80000000, v25
    v_cvt_pk_bf16_f32 v101, v24, v25
    v_lshlrev_b32 v26, 16, v101
    v_and_b32 v27, 0xffff0000, v101
    v_sub_f32 v24, v24, v26
    v_sub_f32 v25, v25, v27
    v_cvt_pk_bf16_f32 v105, v24, v25
    v_mul_f32 v16, v124, v11
    v_mul_f32 v17, v125, v11
    v_exp_f32 v16, v16
    v_fract_f32 v17, v17
    v_mul_f32 v20, v124, v12
    v_mul_f32 v21, v125, v12
    v_cos_f32 v18, v17
    v_sin_f32 v19, v17
    v_exp_f32 v20, v20
    v_fract_f32 v21, v21
    v_mul_f32 v18, v16, v18
    v_mul_f32 v19, v16, v19
    v_cos_f32 v22, v21
    v_sin_f32 v23, v21
    v_cvt_pk_bf16_f32 v110, v18, v19
    v_lshlrev_b32 v24, 16, v110
    v_and_b32 v25, 0xffff0000, v110
    v_sub_f32 v18, v18, v24
    v_sub_f32 v19, v19, v25
    v_cvt_pk_bf16_f32 v114, v18, v19
    v_mul_f32 v22, v20, v22
    v_mul_f32 v23, v20, v23
    v_mul_f32 v24, v126, v22
    v_fma_f32 v24, -v127, v23, v24
    v_mul_f32 v25, v126, v23
    v_fma_f32 v25, v127, v22, v25
    v_xor_b32 v25, 0x80000000, v25
    v_cvt_pk_bf16_f32 v102, v24, v25
    v_lshlrev_b32 v26, 16, v102
    v_and_b32 v27, 0xffff0000, v102
    v_sub_f32 v24, v24, v26
    v_sub_f32 v25, v25, v27
    v_cvt_pk_bf16_f32 v106, v24, v25
    v_mul_f32 v16, v128, v11
    v_mul_f32 v17, v129, v11
    v_exp_f32 v16, v16
    v_fract_f32 v17, v17
    v_mul_f32 v20, v128, v12
    v_mul_f32 v21, v129, v12
    v_cos_f32 v18, v17
    v_sin_f32 v19, v17
    v_exp_f32 v20, v20
    v_fract_f32 v21, v21
    v_mul_f32 v18, v16, v18
    v_mul_f32 v19, v16, v19
    v_cos_f32 v22, v21
    v_sin_f32 v23, v21
    v_cvt_pk_bf16_f32 v111, v18, v19
    v_lshlrev_b32 v24, 16, v111
    v_and_b32 v25, 0xffff0000, v111
    v_sub_f32 v18, v18, v24
    v_sub_f32 v19, v19, v25
    v_cvt_pk_bf16_f32 v115, v18, v19
    v_mul_f32 v22, v20, v22
    v_mul_f32 v23, v20, v23
    v_mul_f32 v24, v130, v22
    v_fma_f32 v24, -v131, v23, v24
    v_mul_f32 v25, v130, v23
    v_fma_f32 v25, v131, v22, v25
    v_xor_b32 v25, 0x80000000, v25
    v_cvt_pk_bf16_f32 v103, v24, v25
    v_lshlrev_b32 v26, 16, v103
    v_and_b32 v27, 0xffff0000, v103
    v_sub_f32 v24, v24, v26
    v_sub_f32 v25, v25, v27
    v_cvt_pk_bf16_f32 v107, v24, v25
    s_nop 1
    v_mfma_f32_32x32x16_bf16 v[68:83], v[100:103], v[108:111], v[68:83]
    v_mfma_f32_32x32x16_bf16 v[68:83], v[100:103], v[112:115], v[68:83]
    v_mfma_f32_32x32x16_bf16 v[68:83], v[104:107], v[108:111], v[68:83]
    ds_read_b128 v[116:119], v14 offset:768
    ds_read_b128 v[120:123], v14 offset:784
    ds_read_b128 v[124:127], v14 offset:800
    ds_read_b128 v[128:131], v14 offset:816
    s_waitcnt lgkmcnt(0)
    v_mul_f32 v16, v116, v11
    v_mul_f32 v17, v117, v11
    v_exp_f32 v16, v16
    v_fract_f32 v17, v17
    v_mul_f32 v20, v116, v12
    v_mul_f32 v21, v117, v12
    v_cos_f32 v18, v17
    v_sin_f32 v19, v17
    v_exp_f32 v20, v20
    v_fract_f32 v21, v21
    v_mul_f32 v18, v16, v18
    v_mul_f32 v19, v16, v19
    v_cos_f32 v22, v21
    v_sin_f32 v23, v21
    v_cvt_pk_bf16_f32 v108, v18, v19
    v_lshlrev_b32 v24, 16, v108
    v_and_b32 v25, 0xffff0000, v108
    v_sub_f32 v18, v18, v24
    v_sub_f32 v19, v19, v25
    v_cvt_pk_bf16_f32 v112, v18, v19
    v_mul_f32 v22, v20, v22
    v_mul_f32 v23, v20, v23
    v_mul_f32 v24, v118, v22
    v_fma_f32 v24, -v119, v23, v24
    v_mul_f32 v25, v118, v23
    v_fma_f32 v25, v119, v22, v25
    v_xor_b32 v25, 0x80000000, v25
    v_cvt_pk_bf16_f32 v100, v24, v25
    v_lshlrev_b32 v26, 16, v100
    v_and_b32 v27, 0xffff0000, v100
    v_sub_f32 v24, v24, v26
    v_sub_f32 v25, v25, v27
    v_cvt_pk_bf16_f32 v104, v24, v25
    v_mul_f32 v16, v120, v11
    v_mul_f32 v17, v121, v11
    v_exp_f32 v16, v16
    v_fract_f32 v17, v17
    v_mul_f32 v20, v120, v12
    v_mul_f32 v21, v121, v12
    v_cos_f32 v18, v17
    v_sin_f32 v19, v17
    v_exp_f32 v20, v20
    v_fract_f32 v21, v21
    v_mul_f32 v18, v16, v18
    v_mul_f32 v19, v16, v19
    v_cos_f32 v22, v21
    v_sin_f32 v23, v21
    v_cvt_pk_bf16_f32 v109, v18, v19
    v_lshlrev_b32 v24, 16, v109
    v_and_b32 v25, 0xffff0000, v109
    v_sub_f32 v18, v18, v24
    v_sub_f32 v19, v19, v25
    v_cvt_pk_bf16_f32 v113, v18, v19
    v_mul_f32 v22, v20, v22
    v_mul_f32 v23, v20, v23
    v_mul_f32 v24, v122, v22
    v_fma_f32 v24, -v123, v23, v24
    v_mul_f32 v25, v122, v23
    v_fma_f32 v25, v123, v22, v25
    v_xor_b32 v25, 0x80000000, v25
    v_cvt_pk_bf16_f32 v101, v24, v25
    v_lshlrev_b32 v26, 16, v101
    v_and_b32 v27, 0xffff0000, v101
    v_sub_f32 v24, v24, v26
    v_sub_f32 v25, v25, v27
    v_cvt_pk_bf16_f32 v105, v24, v25
    v_mul_f32 v16, v124, v11
    v_mul_f32 v17, v125, v11
    v_exp_f32 v16, v16
    v_fract_f32 v17, v17
    v_mul_f32 v20, v124, v12
    v_mul_f32 v21, v125, v12
    v_cos_f32 v18, v17
    v_sin_f32 v19, v17
    v_exp_f32 v20, v20
    v_fract_f32 v21, v21
    v_mul_f32 v18, v16, v18
    v_mul_f32 v19, v16, v19
    v_cos_f32 v22, v21
    v_sin_f32 v23, v21
    v_cvt_pk_bf16_f32 v110, v18, v19
    v_lshlrev_b32 v24, 16, v110
    v_and_b32 v25, 0xffff0000, v110
    v_sub_f32 v18, v18, v24
    v_sub_f32 v19, v19, v25
    v_cvt_pk_bf16_f32 v114, v18, v19
    v_mul_f32 v22, v20, v22
    v_mul_f32 v23, v20, v23
    v_mul_f32 v24, v126, v22
    v_fma_f32 v24, -v127, v23, v24
    v_mul_f32 v25, v126, v23
    v_fma_f32 v25, v127, v22, v25
    v_xor_b32 v25, 0x80000000, v25
    v_cvt_pk_bf16_f32 v102, v24, v25
    v_lshlrev_b32 v26, 16, v102
    v_and_b32 v27, 0xffff0000, v102
    v_sub_f32 v24, v24, v26
    v_sub_f32 v25, v25, v27
    v_cvt_pk_bf16_f32 v106, v24, v25
    v_mul_f32 v16, v128, v11
    v_mul_f32 v17, v129, v11
    v_exp_f32 v16, v16
    v_fract_f32 v17, v17
    v_mul_f32 v20, v128, v12
    v_mul_f32 v21, v129, v12
    v_cos_f32 v18, v17
    v_sin_f32 v19, v17
    v_exp_f32 v20, v20
    v_fract_f32 v21, v21
    v_mul_f32 v18, v16, v18
    v_mul_f32 v19, v16, v19
    v_cos_f32 v22, v21
    v_sin_f32 v23, v21
    v_cvt_pk_bf16_f32 v111, v18, v19
    v_lshlrev_b32 v24, 16, v111
    v_and_b32 v25, 0xffff0000, v111
    v_sub_f32 v18, v18, v24
    v_sub_f32 v19, v19, v25
    v_cvt_pk_bf16_f32 v115, v18, v19
    v_mul_f32 v22, v20, v22
    v_mul_f32 v23, v20, v23
    v_mul_f32 v24, v130, v22
    v_fma_f32 v24, -v131, v23, v24
    v_mul_f32 v25, v130, v23
    v_fma_f32 v25, v131, v22, v25
    v_xor_b32 v25, 0x80000000, v25
    v_cvt_pk_bf16_f32 v103, v24, v25
    v_lshlrev_b32 v26, 16, v103
    v_and_b32 v27, 0xffff0000, v103
    v_sub_f32 v24, v24, v26
    v_sub_f32 v25, v25, v27
    v_cvt_pk_bf16_f32 v107, v24, v25
    s_nop 1
    v_mfma_f32_32x32x16_bf16 v[68:83], v[100:103], v[108:111], v[68:83]
    v_mfma_f32_32x32x16_bf16 v[68:83], v[100:103], v[112:115], v[68:83]
    v_mfma_f32_32x32x16_bf16 v[68:83], v[104:107], v[108:111], v[68:83]
    ds_read_b128 v[116:119], v14 offset:832
    ds_read_b128 v[120:123], v14 offset:848
    ds_read_b128 v[124:127], v14 offset:864
    ds_read_b128 v[128:131], v14 offset:880
    s_waitcnt lgkmcnt(0)
    v_mul_f32 v16, v116, v11
    v_mul_f32 v17, v117, v11
    v_exp_f32 v16, v16
    v_fract_f32 v17, v17
    v_mul_f32 v20, v116, v12
    v_mul_f32 v21, v117, v12
    v_cos_f32 v18, v17
    v_sin_f32 v19, v17
    v_exp_f32 v20, v20
    v_fract_f32 v21, v21
    v_mul_f32 v18, v16, v18
    v_mul_f32 v19, v16, v19
    v_cos_f32 v22, v21
    v_sin_f32 v23, v21
    v_cvt_pk_bf16_f32 v108, v18, v19
    v_lshlrev_b32 v24, 16, v108
    v_and_b32 v25, 0xffff0000, v108
    v_sub_f32 v18, v18, v24
    v_sub_f32 v19, v19, v25
    v_cvt_pk_bf16_f32 v112, v18, v19
    v_mul_f32 v22, v20, v22
    v_mul_f32 v23, v20, v23
    v_mul_f32 v24, v118, v22
    v_fma_f32 v24, -v119, v23, v24
    v_mul_f32 v25, v118, v23
    v_fma_f32 v25, v119, v22, v25
    v_xor_b32 v25, 0x80000000, v25
    v_cvt_pk_bf16_f32 v100, v24, v25
    v_lshlrev_b32 v26, 16, v100
    v_and_b32 v27, 0xffff0000, v100
    v_sub_f32 v24, v24, v26
    v_sub_f32 v25, v25, v27
    v_cvt_pk_bf16_f32 v104, v24, v25
    v_mul_f32 v16, v120, v11
    v_mul_f32 v17, v121, v11
    v_exp_f32 v16, v16
    v_fract_f32 v17, v17
    v_mul_f32 v20, v120, v12
    v_mul_f32 v21, v121, v12
    v_cos_f32 v18, v17
    v_sin_f32 v19, v17
    v_exp_f32 v20, v20
    v_fract_f32 v21, v21
    v_mul_f32 v18, v16, v18
    v_mul_f32 v19, v16, v19
    v_cos_f32 v22, v21
    v_sin_f32 v23, v21
    v_cvt_pk_bf16_f32 v109, v18, v19
    v_lshlrev_b32 v24, 16, v109
    v_and_b32 v25, 0xffff0000, v109
    v_sub_f32 v18, v18, v24
    v_sub_f32 v19, v19, v25
    v_cvt_pk_bf16_f32 v113, v18, v19
    v_mul_f32 v22, v20, v22
    v_mul_f32 v23, v20, v23
    v_mul_f32 v24, v122, v22
    v_fma_f32 v24, -v123, v23, v24
    v_mul_f32 v25, v122, v23
    v_fma_f32 v25, v123, v22, v25
    v_xor_b32 v25, 0x80000000, v25
    v_cvt_pk_bf16_f32 v101, v24, v25
    v_lshlrev_b32 v26, 16, v101
    v_and_b32 v27, 0xffff0000, v101
    v_sub_f32 v24, v24, v26
    v_sub_f32 v25, v25, v27
    v_cvt_pk_bf16_f32 v105, v24, v25
    v_mul_f32 v16, v124, v11
    v_mul_f32 v17, v125, v11
    v_exp_f32 v16, v16
    v_fract_f32 v17, v17
    v_mul_f32 v20, v124, v12
    v_mul_f32 v21, v125, v12
    v_cos_f32 v18, v17
    v_sin_f32 v19, v17
    v_exp_f32 v20, v20
    v_fract_f32 v21, v21
    v_mul_f32 v18, v16, v18
    v_mul_f32 v19, v16, v19
    v_cos_f32 v22, v21
    v_sin_f32 v23, v21
    v_cvt_pk_bf16_f32 v110, v18, v19
    v_lshlrev_b32 v24, 16, v110
    v_and_b32 v25, 0xffff0000, v110
    v_sub_f32 v18, v18, v24
    v_sub_f32 v19, v19, v25
    v_cvt_pk_bf16_f32 v114, v18, v19
    v_mul_f32 v22, v20, v22
    v_mul_f32 v23, v20, v23
    v_mul_f32 v24, v126, v22
    v_fma_f32 v24, -v127, v23, v24
    v_mul_f32 v25, v126, v23
    v_fma_f32 v25, v127, v22, v25
    v_xor_b32 v25, 0x80000000, v25
    v_cvt_pk_bf16_f32 v102, v24, v25
    v_lshlrev_b32 v26, 16, v102
    v_and_b32 v27, 0xffff0000, v102
    v_sub_f32 v24, v24, v26
    v_sub_f32 v25, v25, v27
    v_cvt_pk_bf16_f32 v106, v24, v25
    v_mul_f32 v16, v128, v11
    v_mul_f32 v17, v129, v11
    v_exp_f32 v16, v16
    v_fract_f32 v17, v17
    v_mul_f32 v20, v128, v12
    v_mul_f32 v21, v129, v12
    v_cos_f32 v18, v17
    v_sin_f32 v19, v17
    v_exp_f32 v20, v20
    v_fract_f32 v21, v21
    v_mul_f32 v18, v16, v18
    v_mul_f32 v19, v16, v19
    v_cos_f32 v22, v21
    v_sin_f32 v23, v21
    v_cvt_pk_bf16_f32 v111, v18, v19
    v_lshlrev_b32 v24, 16, v111
    v_and_b32 v25, 0xffff0000, v111
    v_sub_f32 v18, v18, v24
    v_sub_f32 v19, v19, v25
    v_cvt_pk_bf16_f32 v115, v18, v19
    v_mul_f32 v22, v20, v22
    v_mul_f32 v23, v20, v23
    v_mul_f32 v24, v130, v22
    v_fma_f32 v24, -v131, v23, v24
    v_mul_f32 v25, v130, v23
    v_fma_f32 v25, v131, v22, v25
    v_xor_b32 v25, 0x80000000, v25
    v_cvt_pk_bf16_f32 v103, v24, v25
    v_lshlrev_b32 v26, 16, v103
    v_and_b32 v27, 0xffff0000, v103
    v_sub_f32 v24, v24, v26
    v_sub_f32 v25, v25, v27
    v_cvt_pk_bf16_f32 v107, v24, v25
    s_nop 1
    v_mfma_f32_32x32x16_bf16 v[68:83], v[100:103], v[108:111], v[68:83]
    v_mfma_f32_32x32x16_bf16 v[68:83], v[100:103], v[112:115], v[68:83]
    v_mfma_f32_32x32x16_bf16 v[68:83], v[104:107], v[108:111], v[68:83]
    ds_read_b128 v[116:119], v14 offset:896
    ds_read_b128 v[120:123], v14 offset:912
    ds_read_b128 v[124:127], v14 offset:928
    ds_read_b128 v[128:131], v14 offset:944
    s_waitcnt lgkmcnt(0)
    v_mul_f32 v16, v116, v11
    v_mul_f32 v17, v117, v11
    v_exp_f32 v16, v16
    v_fract_f32 v17, v17
    v_mul_f32 v20, v116, v12
    v_mul_f32 v21, v117, v12
    v_cos_f32 v18, v17
    v_sin_f32 v19, v17
    v_exp_f32 v20, v20
    v_fract_f32 v21, v21
    v_mul_f32 v18, v16, v18
    v_mul_f32 v19, v16, v19
    v_cos_f32 v22, v21
    v_sin_f32 v23, v21
    v_cvt_pk_bf16_f32 v108, v18, v19
    v_lshlrev_b32 v24, 16, v108
    v_and_b32 v25, 0xffff0000, v108
    v_sub_f32 v18, v18, v24
    v_sub_f32 v19, v19, v25
    v_cvt_pk_bf16_f32 v112, v18, v19
    v_mul_f32 v22, v20, v22
    v_mul_f32 v23, v20, v23
    v_mul_f32 v24, v118, v22
    v_fma_f32 v24, -v119, v23, v24
    v_mul_f32 v25, v118, v23
    v_fma_f32 v25, v119, v22, v25
    v_xor_b32 v25, 0x80000000, v25
    v_cvt_pk_bf16_f32 v100, v24, v25
    v_lshlrev_b32 v26, 16, v100
    v_and_b32 v27, 0xffff0000, v100
    v_sub_f32 v24, v24, v26
    v_sub_f32 v25, v25, v27
    v_cvt_pk_bf16_f32 v104, v24, v25
    v_mul_f32 v16, v120, v11
    v_mul_f32 v17, v121, v11
    v_exp_f32 v16, v16
    v_fract_f32 v17, v17
    v_mul_f32 v20, v120, v12
    v_mul_f32 v21, v121, v12
    v_cos_f32 v18, v17
    v_sin_f32 v19, v17
    v_exp_f32 v20, v20
    v_fract_f32 v21, v21
    v_mul_f32 v18, v16, v18
    v_mul_f32 v19, v16, v19
    v_cos_f32 v22, v21
    v_sin_f32 v23, v21
    v_cvt_pk_bf16_f32 v109, v18, v19
    v_lshlrev_b32 v24, 16, v109
    v_and_b32 v25, 0xffff0000, v109
    v_sub_f32 v18, v18, v24
    v_sub_f32 v19, v19, v25
    v_cvt_pk_bf16_f32 v113, v18, v19
    v_mul_f32 v22, v20, v22
    v_mul_f32 v23, v20, v23
    v_mul_f32 v24, v122, v22
    v_fma_f32 v24, -v123, v23, v24
    v_mul_f32 v25, v122, v23
    v_fma_f32 v25, v123, v22, v25
    v_xor_b32 v25, 0x80000000, v25
    v_cvt_pk_bf16_f32 v101, v24, v25
    v_lshlrev_b32 v26, 16, v101
    v_and_b32 v27, 0xffff0000, v101
    v_sub_f32 v24, v24, v26
    v_sub_f32 v25, v25, v27
    v_cvt_pk_bf16_f32 v105, v24, v25
    v_mul_f32 v16, v124, v11
    v_mul_f32 v17, v125, v11
    v_exp_f32 v16, v16
    v_fract_f32 v17, v17
    v_mul_f32 v20, v124, v12
    v_mul_f32 v21, v125, v12
    v_cos_f32 v18, v17
    v_sin_f32 v19, v17
    v_exp_f32 v20, v20
    v_fract_f32 v21, v21
    v_mul_f32 v18, v16, v18
    v_mul_f32 v19, v16, v19
    v_cos_f32 v22, v21
    v_sin_f32 v23, v21
    v_cvt_pk_bf16_f32 v110, v18, v19
    v_lshlrev_b32 v24, 16, v110
    v_and_b32 v25, 0xffff0000, v110
    v_sub_f32 v18, v18, v24
    v_sub_f32 v19, v19, v25
    v_cvt_pk_bf16_f32 v114, v18, v19
    v_mul_f32 v22, v20, v22
    v_mul_f32 v23, v20, v23
    v_mul_f32 v24, v126, v22
    v_fma_f32 v24, -v127, v23, v24
    v_mul_f32 v25, v126, v23
    v_fma_f32 v25, v127, v22, v25
    v_xor_b32 v25, 0x80000000, v25
    v_cvt_pk_bf16_f32 v102, v24, v25
    v_lshlrev_b32 v26, 16, v102
    v_and_b32 v27, 0xffff0000, v102
    v_sub_f32 v24, v24, v26
    v_sub_f32 v25, v25, v27
    v_cvt_pk_bf16_f32 v106, v24, v25
    v_mul_f32 v16, v128, v11
    v_mul_f32 v17, v129, v11
    v_exp_f32 v16, v16
    v_fract_f32 v17, v17
    v_mul_f32 v20, v128, v12
    v_mul_f32 v21, v129, v12
    v_cos_f32 v18, v17
    v_sin_f32 v19, v17
    v_exp_f32 v20, v20
    v_fract_f32 v21, v21
    v_mul_f32 v18, v16, v18
    v_mul_f32 v19, v16, v19
    v_cos_f32 v22, v21
    v_sin_f32 v23, v21
    v_cvt_pk_bf16_f32 v111, v18, v19
    v_lshlrev_b32 v24, 16, v111
    v_and_b32 v25, 0xffff0000, v111
    v_sub_f32 v18, v18, v24
    v_sub_f32 v19, v19, v25
    v_cvt_pk_bf16_f32 v115, v18, v19
    v_mul_f32 v22, v20, v22
    v_mul_f32 v23, v20, v23
    v_mul_f32 v24, v130, v22
    v_fma_f32 v24, -v131, v23, v24
    v_mul_f32 v25, v130, v23
    v_fma_f32 v25, v131, v22, v25
    v_xor_b32 v25, 0x80000000, v25
    v_cvt_pk_bf16_f32 v103, v24, v25
    v_lshlrev_b32 v26, 16, v103
    v_and_b32 v27, 0xffff0000, v103
    v_sub_f32 v24, v24, v26
    v_sub_f32 v25, v25, v27
    v_cvt_pk_bf16_f32 v107, v24, v25
    s_nop 1
    v_mfma_f32_32x32x16_bf16 v[68:83], v[100:103], v[108:111], v[68:83]
    v_mfma_f32_32x32x16_bf16 v[68:83], v[100:103], v[112:115], v[68:83]
    v_mfma_f32_32x32x16_bf16 v[68:83], v[104:107], v[108:111], v[68:83]
    ds_read_b128 v[116:119], v14 offset:960
    ds_read_b128 v[120:123], v14 offset:976
    ds_read_b128 v[124:127], v14 offset:992
    ds_read_b128 v[128:131], v14 offset:1008
    s_waitcnt lgkmcnt(0)
    v_mul_f32 v16, v116, v11
    v_mul_f32 v17, v117, v11
    v_exp_f32 v16, v16
    v_fract_f32 v17, v17
    v_mul_f32 v20, v116, v12
    v_mul_f32 v21, v117, v12
    v_cos_f32 v18, v17
    v_sin_f32 v19, v17
    v_exp_f32 v20, v20
    v_fract_f32 v21, v21
    v_mul_f32 v18, v16, v18
    v_mul_f32 v19, v16, v19
    v_cos_f32 v22, v21
    v_sin_f32 v23, v21
    v_cvt_pk_bf16_f32 v108, v18, v19
    v_lshlrev_b32 v24, 16, v108
    v_and_b32 v25, 0xffff0000, v108
    v_sub_f32 v18, v18, v24
    v_sub_f32 v19, v19, v25
    v_cvt_pk_bf16_f32 v112, v18, v19
    v_mul_f32 v22, v20, v22
    v_mul_f32 v23, v20, v23
    v_mul_f32 v24, v118, v22
    v_fma_f32 v24, -v119, v23, v24
    v_mul_f32 v25, v118, v23
    v_fma_f32 v25, v119, v22, v25
    v_xor_b32 v25, 0x80000000, v25
    v_cvt_pk_bf16_f32 v100, v24, v25
    v_lshlrev_b32 v26, 16, v100
    v_and_b32 v27, 0xffff0000, v100
    v_sub_f32 v24, v24, v26
    v_sub_f32 v25, v25, v27
    v_cvt_pk_bf16_f32 v104, v24, v25
    v_mul_f32 v16, v120, v11
    v_mul_f32 v17, v121, v11
    v_exp_f32 v16, v16
    v_fract_f32 v17, v17
    v_mul_f32 v20, v120, v12
    v_mul_f32 v21, v121, v12
    v_cos_f32 v18, v17
    v_sin_f32 v19, v17
    v_exp_f32 v20, v20
    v_fract_f32 v21, v21
    v_mul_f32 v18, v16, v18
    v_mul_f32 v19, v16, v19
    v_cos_f32 v22, v21
    v_sin_f32 v23, v21
    v_cvt_pk_bf16_f32 v109, v18, v19
    v_lshlrev_b32 v24, 16, v109
    v_and_b32 v25, 0xffff0000, v109
    v_sub_f32 v18, v18, v24
    v_sub_f32 v19, v19, v25
    v_cvt_pk_bf16_f32 v113, v18, v19
    v_mul_f32 v22, v20, v22
    v_mul_f32 v23, v20, v23
    v_mul_f32 v24, v122, v22
    v_fma_f32 v24, -v123, v23, v24
    v_mul_f32 v25, v122, v23
    v_fma_f32 v25, v123, v22, v25
    v_xor_b32 v25, 0x80000000, v25
    v_cvt_pk_bf16_f32 v101, v24, v25
    v_lshlrev_b32 v26, 16, v101
    v_and_b32 v27, 0xffff0000, v101
    v_sub_f32 v24, v24, v26
    v_sub_f32 v25, v25, v27
    v_cvt_pk_bf16_f32 v105, v24, v25
    v_mul_f32 v16, v124, v11
    v_mul_f32 v17, v125, v11
    v_exp_f32 v16, v16
    v_fract_f32 v17, v17
    v_mul_f32 v20, v124, v12
    v_mul_f32 v21, v125, v12
    v_cos_f32 v18, v17
    v_sin_f32 v19, v17
    v_exp_f32 v20, v20
    v_fract_f32 v21, v21
    v_mul_f32 v18, v16, v18
    v_mul_f32 v19, v16, v19
    v_cos_f32 v22, v21
    v_sin_f32 v23, v21
    v_cvt_pk_bf16_f32 v110, v18, v19
    v_lshlrev_b32 v24, 16, v110
    v_and_b32 v25, 0xffff0000, v110
    v_sub_f32 v18, v18, v24
    v_sub_f32 v19, v19, v25
    v_cvt_pk_bf16_f32 v114, v18, v19
    v_mul_f32 v22, v20, v22
    v_mul_f32 v23, v20, v23
    v_mul_f32 v24, v126, v22
    v_fma_f32 v24, -v127, v23, v24
    v_mul_f32 v25, v126, v23
    v_fma_f32 v25, v127, v22, v25
    v_xor_b32 v25, 0x80000000, v25
    v_cvt_pk_bf16_f32 v102, v24, v25
    v_lshlrev_b32 v26, 16, v102
    v_and_b32 v27, 0xffff0000, v102
    v_sub_f32 v24, v24, v26
    v_sub_f32 v25, v25, v27
    v_cvt_pk_bf16_f32 v106, v24, v25
    v_mul_f32 v16, v128, v11
    v_mul_f32 v17, v129, v11
    v_exp_f32 v16, v16
    v_fract_f32 v17, v17
    v_mul_f32 v20, v128, v12
    v_mul_f32 v21, v129, v12
    v_cos_f32 v18, v17
    v_sin_f32 v19, v17
    v_exp_f32 v20, v20
    v_fract_f32 v21, v21
    v_mul_f32 v18, v16, v18
    v_mul_f32 v19, v16, v19
    v_cos_f32 v22, v21
    v_sin_f32 v23, v21
    v_cvt_pk_bf16_f32 v111, v18, v19
    v_lshlrev_b32 v24, 16, v111
    v_and_b32 v25, 0xffff0000, v111
    v_sub_f32 v18, v18, v24
    v_sub_f32 v19, v19, v25
    v_cvt_pk_bf16_f32 v115, v18, v19
    v_mul_f32 v22, v20, v22
    v_mul_f32 v23, v20, v23
    v_mul_f32 v24, v130, v22
    v_fma_f32 v24, -v131, v23, v24
    v_mul_f32 v25, v130, v23
    v_fma_f32 v25, v131, v22, v25
    v_xor_b32 v25, 0x80000000, v25
    v_cvt_pk_bf16_f32 v103, v24, v25
    v_lshlrev_b32 v26, 16, v103
    v_and_b32 v27, 0xffff0000, v103
    v_sub_f32 v24, v24, v26
    v_sub_f32 v25, v25, v27
    v_cvt_pk_bf16_f32 v107, v24, v25
    s_nop 1
    v_mfma_f32_32x32x16_bf16 v[68:83], v[100:103], v[108:111], v[68:83]
    v_mfma_f32_32x32x16_bf16 v[68:83], v[100:103], v[112:115], v[68:83]
    v_mfma_f32_32x32x16_bf16 v[68:83], v[104:107], v[108:111], v[68:83]
    s_nop 15
    s_nop 3
    v_and_b32 v16, 31, v0
    v_lshlrev_b32 v16, 4, v16
    v_add_u32 v16, 109248, v16
    s_mul_i32 s7, s3, 4608
    v_add_u32 v16, s7, v16
    v_cmp_lt_u32 vcc, 31, v0
    v_mov_b32 v17, 0
    v_mov_b32 v18, 8
    v_cndmask_b32 v17, v17, v18, vcc
    v_add_u32 v17, v17, v16
    v_add_f32 v19, v68, v68
    v_cvt_pk_bf16_f32 v19, v19, v19
    ds_write_b16 v17, v19
    v_mov_b32 v17, 2
    v_mov_b32 v18, 10
    v_cndmask_b32 v17, v17, v18, vcc
    v_add_u32 v17, v17, v16
    v_add_f32 v19, v69, v69
    v_cvt_pk_bf16_f32 v19, v19, v19
    ds_write_b16 v17, v19
    v_mov_b32 v17, 4
    v_mov_b32 v18, 12
    v_cndmask_b32 v17, v17, v18, vcc
    v_add_u32 v17, v17, v16
    v_add_f32 v19, v70, v70
    v_cvt_pk_bf16_f32 v19, v19, v19
    ds_write_b16 v17, v19
    v_mov_b32 v17, 6
    v_mov_b32 v18, 14
    v_cndmask_b32 v17, v17, v18, vcc
    v_add_u32 v17, v17, v16
    v_add_f32 v19, v71, v71
    v_cvt_pk_bf16_f32 v19, v19, v19
    ds_write_b16 v17, v19
    v_mov_b32 v17, 512
    v_mov_b32 v18, 1024
    v_cndmask_b32 v17, v17, v18, vcc
    v_add_u32 v17, v17, v16
    v_add_f32 v19, v72, v72
    v_cvt_pk_bf16_f32 v19, v19, v19
    ds_write_b16 v17, v19
    v_mov_b32 v17, 516
    v_mov_b32 v18, 1032
    v_cndmask_b32 v17, v17, v18, vcc
    v_add_u32 v17, v17, v16
    v_add_f32 v19, v73, v73
    v_cvt_pk_bf16_f32 v19, v19, v19
    ds_write_b16 v17, v19
    v_mov_b32 v17, 520
    v_mov_b32 v18, 1536
    v_cndmask_b32 v17, v17, v18, vcc
    v_add_u32 v17, v17, v16
    v_add_f32 v19, v74, v74
    v_cvt_pk_bf16_f32 v19, v19, v19
    ds_write_b16 v17, v19
    v_mov_b32 v17, 524
    v_mov_b32 v18, 1544
    v_cndmask_b32 v17, v17, v18, vcc
    v_add_u32 v17, v17, v16
    v_add_f32 v19, v75, v75
    v_cvt_pk_bf16_f32 v19, v19, v19
    ds_write_b16 v17, v19
    v_mov_b32 v17, 2048
    v_mov_b32 v18, 4096
    v_cndmask_b32 v17, v17, v18, vcc
    v_add_u32 v17, v17, v16
    v_add_f32 v19, v76, v76
    v_cvt_pk_bf16_f32 v19, v19, v19
    ds_write_b16 v17, v19
    v_mov_b32 v17, 2560
    v_mov_b32 v18, 4104
    v_cndmask_b32 v17, v17, v18, vcc
    v_add_u32 v17, v17, v16
    v_add_f32 v19, v77, v77
    v_cvt_pk_bf16_f32 v19, v19, v19
    ds_write_b16 v17, v19
    v_mov_b32 v17, 3072
    v_mov_b32 v18, 4104
    v_cndmask_b32 v17, v17, v18, vcc
    v_add_u32 v17, v17, v16
    v_add_f32 v19, v78, v78
    v_cvt_pk_bf16_f32 v19, v19, v19
    ds_write_b16 v17, v19
    v_mov_b32 v17, 3584
    v_mov_b32 v18, 4104
    v_cndmask_b32 v17, v17, v18, vcc
    v_add_u32 v17, v17, v16
    v_add_f32 v19, v79, v79
    v_cvt_pk_bf16_f32 v19, v19, v19
    ds_write_b16 v17, v19
    s_waitcnt lgkmcnt(0)
    v_lshrrev_b32 v26, 2, v0
    v_mul_u32_u24 v26, 80, v26
    v_and_b32 v27, 3, v0
    v_lshlrev_b32 v27, 4, v27
    v_add3_u32 v26, v26, v27, s6
    v_mov_b32 v27, 109248
    v_add_u32 v27, s7, v27
    v_lshlrev_b32 v16, 3, v0
    v_add_u32 v16, 7, v16
    v_cvt_f32_u32 v16, v16
    v_cvt_pk_bf16_f32 v16, v16, v16
    v_and_b32 v16, 0xffff0000, v16
    v_cvt_u32_f32 v16, v16
    v_lshl_add_u32 v16, v16, 1, v27
    ds_read_u16 v116, v16
    v_lshlrev_b32 v16, 3, v0
    v_add_u32 v16, 6, v16
    v_cvt_f32_u32 v16, v16
    v_cvt_pk_bf16_f32 v16, v16, v16
    v_and_b32 v16, 0xffff0000, v16
    v_cvt_u32_f32 v16, v16
    v_lshl_add_u32 v16, v16, 1, v27
    ds_read_u16 v117, v16
    v_lshlrev_b32 v16, 3, v0
    v_add_u32 v16, 5, v16
    v_cvt_f32_u32 v16, v16
    v_cvt_pk_bf16_f32 v16, v16, v16
    v_and_b32 v16, 0xffff0000, v16
    v_cvt_u32_f32 v16, v16
    v_lshl_add_u32 v16, v16, 1, v27
    ds_read_u16 v118, v16
    v_lshlrev_b32 v16, 3, v0
    v_add_u32 v16, 4, v16
    v_cvt_f32_u32 v16, v16
    v_cvt_pk_bf16_f32 v16, v16, v16
    v_and_b32 v16, 0xffff0000, v16
    v_cvt_u32_f32 v16, v16
    v_lshl_add_u32 v16, v16, 1, v27
    ds_read_u16 v119, v16
    v_lshlrev_b32 v16, 3, v0
    v_add_u32 v16, 3, v16
    v_cvt_f32_u32 v16, v16
    v_cvt_pk_bf16_f32 v16, v16, v16
    v_and_b32 v16, 0xffff0000, v16
    v_cvt_u32_f32 v16, v16
    v_lshl_add_u32 v16, v16, 1, v27
    ds_read_u16 v120, v16
    v_lshlrev_b32 v16, 3, v0
    v_add_u32 v16, 2, v16
    v_cvt_f32_u32 v16, v16
    v_cvt_pk_bf16_f32 v16, v16, v16
    v_and_b32 v16, 0xffff0000, v16
    v_cvt_u32_f32 v16, v16
    v_lshl_add_u32 v16, v16, 1, v27
    ds_read_u16 v121, v16
    v_lshlrev_b32 v16, 3, v0
    v_add_u32 v16, 1, v16
    v_cvt_f32_u32 v16, v16
    v_cvt_pk_bf16_f32 v16, v16, v16
    v_and_b32 v16, 0xffff0000, v16
    v_cvt_u32_f32 v16, v16
    v_lshl_add_u32 v16, v16, 1, v27
    ds_read_u16 v122, v16
    v_lshlrev_b32 v16, 3, v0
    v_add_u32 v16, 0, v16
    v_cvt_f32_u32 v16, v16
    v_cvt_pk_bf16_f32 v16, v16, v16
    v_and_b32 v16, 0xffff0000, v16
    v_cvt_u32_f32 v16, v16
    v_lshl_add_u32 v16, v16, 1, v27
    ds_read_u16 v123, v16
    s_waitcnt lgkmcnt(0)
    v_lshl_or_b32 v20, v117, 16, v116
    v_lshl_or_b32 v21, v119, 16, v118
    v_lshl_or_b32 v22, v121, 16, v120
    v_lshl_or_b32 v23, v123, 16, v122
    ds_write_b128 v26, v[20:23] offset:20144
    v_lshlrev_b32 v16, 3, v0
    v_add_u32 v16, 519, v16
    v_cvt_f32_u32 v16, v16
    v_cvt_pk_bf16_f32 v16, v16, v16
    v_and_b32 v16, 0xffff0000, v16
    v_cvt_u32_f32 v16, v16
    v_lshl_add_u32 v16, v16, 1, v27
    ds_read_u16 v116, v16
    v_lshlrev_b32 v16, 3, v0
    v_add_u32 v16, 518, v16
    v_cvt_f32_u32 v16, v16
    v_cvt_pk_bf16_f32 v16, v16, v16
    v_and_b32 v16, 0xffff0000, v16
    v_cvt_u32_f32 v16, v16
    v_lshl_add_u32 v16, v16, 1, v27
    ds_read_u16 v117, v16
    v_lshlrev_b32 v16, 3, v0
    v_add_u32 v16, 517, v16
    v_cvt_f32_u32 v16, v16
    v_cvt_pk_bf16_f32 v16, v16, v16
    v_and_b32 v16, 0xffff0000, v16
    v_cvt_u32_f32 v16, v16
    v_lshl_add_u32 v16, v16, 1, v27
    ds_read_u16 v118, v16
    v_lshlrev_b32 v16, 3, v0
    v_add_u32 v16, 516, v16
    v_cvt_f32_u32 v16, v16
    v_cvt_pk_bf16_f32 v16, v16, v16
    v_and_b32 v16, 0xffff0000, v16
    v_cvt_u32_f32 v16, v16
    v_lshl_add_u32 v16, v16, 1, v27
    ds_read_u16 v119, v16
    v_lshlrev_b32 v16, 3, v0
    v_add_u32 v16, 515, v16
    v_cvt_f32_u32 v16, v16
    v_cvt_pk_bf16_f32 v16, v16, v16
    v_and_b32 v16, 0xffff0000, v16
    v_cvt_u32_f32 v16, v16
    v_lshl_add_u32 v16, v16, 1, v27
    ds_read_u16 v120, v16
    v_lshlrev_b32 v16, 3, v0
    v_add_u32 v16, 514, v16
    v_cvt_f32_u32 v16, v16
    v_cvt_pk_bf16_f32 v16, v16, v16
    v_and_b32 v16, 0xffff0000, v16
    v_cvt_u32_f32 v16, v16
    v_lshl_add_u32 v16, v16, 1, v27
    ds_read_u16 v121, v16
    v_lshlrev_b32 v16, 3, v0
    v_add_u32 v16, 513, v16
    v_cvt_f32_u32 v16, v16
    v_cvt_pk_bf16_f32 v16, v16, v16
    v_and_b32 v16, 0xffff0000, v16
    v_cvt_u32_f32 v16, v16
    v_lshl_add_u32 v16, v16, 1, v27
    ds_read_u16 v122, v16
    v_lshlrev_b32 v16, 3, v0
    v_add_u32 v16, 512, v16
    v_cvt_f32_u32 v16, v16
    v_cvt_pk_bf16_f32 v16, v16, v16
    v_and_b32 v16, 0xffff0000, v16
    v_cvt_u32_f32 v16, v16
    v_lshl_add_u32 v16, v16, 1, v27
    ds_read_u16 v123, v16
    s_waitcnt lgkmcnt(0)
    v_lshl_or_b32 v20, v117, 16, v116
    v_lshl_or_b32 v21, v119, 16, v118
    v_lshl_or_b32 v22, v121, 16, v120
    v_lshl_or_b32 v23, v123, 16, v122
    ds_write_b128 v26, v[20:23] offset:21424
    v_lshlrev_b32 v16, 3, v0
    v_add_u32 v16, 1031, v16
    v_cvt_f32_u32 v16, v16
    v_cvt_pk_bf16_f32 v16, v16, v16
    v_and_b32 v16, 0xffff0000, v16
    v_cvt_u32_f32 v16, v16
    v_lshl_add_u32 v16, v16, 1, v27
    ds_read_u16 v116, v16
    v_lshlrev_b32 v16, 3, v0
    v_add_u32 v16, 1030, v16
    v_cvt_f32_u32 v16, v16
    v_cvt_pk_bf16_f32 v16, v16, v16
    v_and_b32 v16, 0xffff0000, v16
    v_cvt_u32_f32 v16, v16
    v_lshl_add_u32 v16, v16, 1, v27
    ds_read_u16 v117, v16
    v_lshlrev_b32 v16, 3, v0
    v_add_u32 v16, 1029, v16
    v_cvt_f32_u32 v16, v16
    v_cvt_pk_bf16_f32 v16, v16, v16
    v_and_b32 v16, 0xffff0000, v16
    v_cvt_u32_f32 v16, v16
    v_lshl_add_u32 v16, v16, 1, v27
    ds_read_u16 v118, v16
    v_lshlrev_b32 v16, 3, v0
    v_add_u32 v16, 1028, v16
    v_cvt_f32_u32 v16, v16
    v_cvt_pk_bf16_f32 v16, v16, v16
    v_and_b32 v16, 0xffff0000, v16
    v_cvt_u32_f32 v16, v16
    v_lshl_add_u32 v16, v16, 1, v27
    ds_read_u16 v119, v16
    v_lshlrev_b32 v16, 3, v0
    v_add_u32 v16, 1027, v16
    v_cvt_f32_u32 v16, v16
    v_cvt_pk_bf16_f32 v16, v16, v16
    v_and_b32 v16, 0xffff0000, v16
    v_cvt_u32_f32 v16, v16
    v_lshl_add_u32 v16, v16, 1, v27
    ds_read_u16 v120, v16
    v_lshlrev_b32 v16, 3, v0
    v_add_u32 v16, 1026, v16
    v_cvt_f32_u32 v16, v16
    v_cvt_pk_bf16_f32 v16, v16, v16
    v_and_b32 v16, 0xffff0000, v16
    v_cvt_u32_f32 v16, v16
    v_lshl_add_u32 v16, v16, 1, v27
    ds_read_u16 v121, v16
    v_lshlrev_b32 v16, 3, v0
    v_add_u32 v16, 1025, v16
    v_cvt_f32_u32 v16, v16
    v_cvt_pk_bf16_f32 v16, v16, v16
    v_and_b32 v16, 0xffff0000, v16
    v_cvt_u32_f32 v16, v16
    v_lshl_add_u32 v16, v16, 1, v27
    ds_read_u16 v122, v16
    v_lshlrev_b32 v16, 3, v0
    v_add_u32 v16, 1024, v16
    v_cvt_f32_u32 v16, v16
    v_cvt_pk_bf16_f32 v16, v16, v16
    v_and_b32 v16, 0xffff0000, v16
    v_cvt_u32_f32 v16, v16
    v_lshl_add_u32 v16, v16, 1, v27
    ds_read_u16 v123, v16
    s_waitcnt lgkmcnt(0)
    v_lshl_or_b32 v20, v117, 16, v116
    v_lshl_or_b32 v21, v119, 16, v118
    v_lshl_or_b32 v22, v121, 16, v120
    v_lshl_or_b32 v23, v123, 16, v122
    ds_write_b128 v26, v[20:23] offset:22704
    v_lshlrev_b32 v16, 3, v0
    v_add_u32 v16, 1543, v16
    v_cvt_f32_u32 v16, v16
    v_cvt_pk_bf16_f32 v16, v16, v16
    v_and_b32 v16, 0xffff0000, v16
    v_cvt_u32_f32 v16, v16
    v_lshl_add_u32 v16, v16, 1, v27
    ds_read_u16 v116, v16
    v_lshlrev_b32 v16, 3, v0
    v_add_u32 v16, 1542, v16
    v_cvt_f32_u32 v16, v16
    v_cvt_pk_bf16_f32 v16, v16, v16
    v_and_b32 v16, 0xffff0000, v16
    v_cvt_u32_f32 v16, v16
    v_lshl_add_u32 v16, v16, 1, v27
    ds_read_u16 v117, v16
    v_lshlrev_b32 v16, 3, v0
    v_add_u32 v16, 1541, v16
    v_cvt_f32_u32 v16, v16
    v_cvt_pk_bf16_f32 v16, v16, v16
    v_and_b32 v16, 0xffff0000, v16
    v_cvt_u32_f32 v16, v16
    v_lshl_add_u32 v16, v16, 1, v27
    ds_read_u16 v118, v16
    v_lshlrev_b32 v16, 3, v0
    v_add_u32 v16, 1540, v16
    v_cvt_f32_u32 v16, v16
    v_cvt_pk_bf16_f32 v16, v16, v16
    v_and_b32 v16, 0xffff0000, v16
    v_cvt_u32_f32 v16, v16
    v_lshl_add_u32 v16, v16, 1, v27
    ds_read_u16 v119, v16
    v_lshlrev_b32 v16, 3, v0
    v_add_u32 v16, 1539, v16
    v_cvt_f32_u32 v16, v16
    v_cvt_pk_bf16_f32 v16, v16, v16
    v_and_b32 v16, 0xffff0000, v16
    v_cvt_u32_f32 v16, v16
    v_lshl_add_u32 v16, v16, 1, v27
    ds_read_u16 v120, v16
    v_lshlrev_b32 v16, 3, v0
    v_add_u32 v16, 1538, v16
    v_cvt_f32_u32 v16, v16
    v_cvt_pk_bf16_f32 v16, v16, v16
    v_and_b32 v16, 0xffff0000, v16
    v_cvt_u32_f32 v16, v16
    v_lshl_add_u32 v16, v16, 1, v27
    ds_read_u16 v121, v16
    v_lshlrev_b32 v16, 3, v0
    v_add_u32 v16, 1537, v16
    v_cvt_f32_u32 v16, v16
    v_cvt_pk_bf16_f32 v16, v16, v16
    v_and_b32 v16, 0xffff0000, v16
    v_cvt_u32_f32 v16, v16
    v_lshl_add_u32 v16, v16, 1, v27
    ds_read_u16 v122, v16
    v_lshlrev_b32 v16, 3, v0
    v_add_u32 v16, 1536, v16
    v_cvt_f32_u32 v16, v16
    v_cvt_pk_bf16_f32 v16, v16, v16
    v_and_b32 v16, 0xffff0000, v16
    v_cvt_u32_f32 v16, v16
    v_lshl_add_u32 v16, v16, 1, v27
    ds_read_u16 v123, v16
    s_waitcnt lgkmcnt(0)
    v_lshl_or_b32 v20, v117, 16, v116
    v_lshl_or_b32 v21, v119, 16, v118
    v_lshl_or_b32 v22, v121, 16, v120
    v_lshl_or_b32 v23, v123, 16, v122
    ds_write_b128 v26, v[20:23] offset:23984
    s_waitcnt lgkmcnt(0)
    s_barrier
    s_waitcnt vmcnt(0)
    ds_write_b16 v1, v36 offset:72
    ds_write_b16 v1, v36 offset:4490
    ds_write_b16 v1, v36 offset:8908
    ds_write_b16 v1, v36 offset:13326
    ds_write_b16_d16_hi v1, v36 offset:25336
    ds_write_b16_d16_hi v1, v36 offset:29754
    ds_write_b16_d16_hi v1, v36 offset:34172
    ds_write_b16_d16_hi v1, v36 offset:38590
    ds_write_b16 v2, v37 offset:72
    ds_write_b16 v2, v37 offset:4490
    ds_write_b16 v2, v37 offset:8908
    ds_write_b16 v2, v37 offset:13326
    ds_write_b16_d16_hi v2, v37 offset:25336
    ds_write_b16_d16_hi v2, v37 offset:29754
    ds_write_b16_d16_hi v2, v37 offset:34172
    ds_write_b16_d16_hi v2, v37 offset:38590
    ds_write_b16 v1, v38 offset:200
    ds_write_b16 v1, v38 offset:4618
    ds_write_b16 v1, v38 offset:9036
    ds_write_b16 v1, v38 offset:13454
    ds_write_b16_d16_hi v1, v38 offset:25464
    ds_write_b16_d16_hi v1, v38 offset:29882
    ds_write_b16_d16_hi v1, v38 offset:34300
    ds_write_b16_d16_hi v1, v38 offset:38718
    ds_write_b16 v2, v39 offset:200
    ds_write_b16 v2, v39 offset:4618
    ds_write_b16 v2, v39 offset:9036
    ds_write_b16 v2, v39 offset:13454
    ds_write_b16_d16_hi v2, v39 offset:25464
    ds_write_b16_d16_hi v2, v39 offset:29882
    ds_write_b16_d16_hi v2, v39 offset:34300
    ds_write_b16_d16_hi v2, v39 offset:38718
    ds_write_b16 v1, v40 offset:328
    ds_write_b16 v1, v40 offset:4746
    ds_write_b16 v1, v40 offset:9164
    ds_write_b16 v1, v40 offset:13582
    ds_write_b16_d16_hi v1, v40 offset:25592
    ds_write_b16_d16_hi v1, v40 offset:30010
    ds_write_b16_d16_hi v1, v40 offset:34428
    ds_write_b16_d16_hi v1, v40 offset:38846
    ds_write_b16 v2, v41 offset:328
    ds_write_b16 v2, v41 offset:4746
    ds_write_b16 v2, v41 offset:9164
    ds_write_b16 v2, v41 offset:13582
    ds_write_b16_d16_hi v2, v41 offset:25592
    ds_write_b16_d16_hi v2, v41 offset:30010
    ds_write_b16_d16_hi v2, v41 offset:34428
    ds_write_b16_d16_hi v2, v41 offset:38846
    ds_write_b16 v1, v42 offset:456
    ds_write_b16 v1, v42 offset:4874
    ds_write_b16 v1, v42 offset:9292
    ds_write_b16 v1, v42 offset:13710
    ds_write_b16_d16_hi v1, v42 offset:25720
    ds_write_b16_d16_hi v1, v42 offset:30138
    ds_write_b16_d16_hi v1, v42 offset:34556
    ds_write_b16_d16_hi v1, v42 offset:38974
    ds_write_b16 v2, v43 offset:456
    ds_write_b16 v2, v43 offset:4874
    ds_write_b16 v2, v43 offset:9292
    ds_write_b16 v2, v43 offset:13710
    ds_write_b16_d16_hi v2, v43 offset:25720
    ds_write_b16_d16_hi v2, v43 offset:30138
    ds_write_b16_d16_hi v2, v43 offset:34556
    ds_write_b16_d16_hi v2, v43 offset:38974
    ds_write_b16 v1, v44 offset:584
    ds_write_b16 v1, v44 offset:5002
    ds_write_b16 v1, v44 offset:9420
    ds_write_b16 v1, v44 offset:13838
    ds_write_b16_d16_hi v1, v44 offset:25848
    ds_write_b16_d16_hi v1, v44 offset:30266
    ds_write_b16_d16_hi v1, v44 offset:34684
    ds_write_b16_d16_hi v1, v44 offset:39102
    ds_write_b16 v2, v45 offset:584
    ds_write_b16 v2, v45 offset:5002
    ds_write_b16 v2, v45 offset:9420
    ds_write_b16 v2, v45 offset:13838
    ds_write_b16_d16_hi v2, v45 offset:25848
    ds_write_b16_d16_hi v2, v45 offset:30266
    ds_write_b16_d16_hi v2, v45 offset:34684
    ds_write_b16_d16_hi v2, v45 offset:39102
    ds_write_b16 v1, v46 offset:712
    ds_write_b16 v1, v46 offset:5130
    ds_write_b16 v1, v46 offset:9548
    ds_write_b16 v1, v46 offset:13966
    ds_write_b16_d16_hi v1, v46 offset:25976
    ds_write_b16_d16_hi v1, v46 offset:30394
    ds_write_b16_d16_hi v1, v46 offset:34812
    ds_write_b16_d16_hi v1, v46 offset:39230
    ds_write_b16 v2, v47 offset:712
    ds_write_b16 v2, v47 offset:5130
    ds_write_b16 v2, v47 offset:9548
    ds_write_b16 v2, v47 offset:13966
    ds_write_b16_d16_hi v2, v47 offset:25976
    ds_write_b16_d16_hi v2, v47 offset:30394
    ds_write_b16_d16_hi v2, v47 offset:34812
    ds_write_b16_d16_hi v2, v47 offset:39230
    ds_write_b16 v1, v48 offset:840
    ds_write_b16 v1, v48 offset:5258
    ds_write_b16 v1, v48 offset:9676
    ds_write_b16 v1, v48 offset:14094
    ds_write_b16_d16_hi v1, v48 offset:26104
    ds_write_b16_d16_hi v1, v48 offset:30522
    ds_write_b16_d16_hi v1, v48 offset:34940
    ds_write_b16_d16_hi v1, v48 offset:39358
    ds_write_b16 v2, v49 offset:840
    ds_write_b16 v2, v49 offset:5258
    ds_write_b16 v2, v49 offset:9676
    ds_write_b16 v2, v49 offset:14094
    ds_write_b16_d16_hi v2, v49 offset:26104
    ds_write_b16_d16_hi v2, v49 offset:30522
    ds_write_b16_d16_hi v2, v49 offset:34940
    ds_write_b16_d16_hi v2, v49 offset:39358
    ds_write_b16 v1, v50 offset:968
    ds_write_b16 v1, v50 offset:5386
    ds_write_b16 v1, v50 offset:9804
    ds_write_b16 v1, v50 offset:14222
    ds_write_b16_d16_hi v1, v50 offset:26232
    ds_write_b16_d16_hi v1, v50 offset:30650
    ds_write_b16_d16_hi v1, v50 offset:35068
    ds_write_b16_d16_hi v1, v50 offset:39486
    ds_write_b16 v2, v51 offset:968
    ds_write_b16 v2, v51 offset:5386
    ds_write_b16 v2, v51 offset:9804
    ds_write_b16 v2, v51 offset:14222
    ds_write_b16_d16_hi v2, v51 offset:26232
    ds_write_b16_d16_hi v2, v51 offset:30650
    ds_write_b16_d16_hi v2, v51 offset:35068
    ds_write_b16_d16_hi v2, v51 offset:39486
    s_waitcnt lgkmcnt(0)
    s_barrier
    v_mov_b32 v68, 0
    v_mov_b32 v69, 0
    v_mov_b32 v70, 0
    v_mov_b32 v71, 0
    v_mov_b32 v72, 0
    v_mov_b32 v73, 0
    v_mov_b32 v74, 0
    v_mov_b32 v75, 0
    v_mov_b32 v76, 0
    v_mov_b32 v77, 0
    v_mov_b32 v78, 0
    v_mov_b32 v79, 0
    v_mov_b32 v80, 0
    v_mov_b32 v81, 0
    v_mov_b32 v82, 0
    v_mov_b32 v83, 0
    v_mov_b32 v84, 0
    v_mov_b32 v85, 0
    v_mov_b32 v86, 0
    v_mov_b32 v87, 0
    v_mov_b32 v88, 0
    v_mov_b32 v89, 0
    v_mov_b32 v90, 0
    v_mov_b32 v91, 0
    v_mov_b32 v92, 0
    v_mov_b32 v93, 0
    v_mov_b32 v94, 0
    v_mov_b32 v95, 0
    v_mov_b32 v96, 0
    v_mov_b32 v97, 0
    v_mov_b32 v98, 0
    v_mov_b32 v99, 0
    ds_read_b64 v[100:101], v3 offset:32
    ds_read_b64 v[102:103], v3 offset:40
    ds_read_b128 v[104:107], v4 offset:5040
    ds_read_b128 v[108:111], v4 offset:2480
    ds_read_b64 v[112:113], v3 offset:0
    ds_read_b64 v[114:115], v3 offset:8
    ds_read_b128 v[116:119], v4 offset:5072
    ds_read_b128 v[120:123], v4 offset:2512
    ds_read_b64 v[124:125], v3 offset:96
    ds_read_b64 v[126:127], v3 offset:104
    ds_read_b128 v[128:131], v4 offset:4960
    ds_read_b128 v[132:135], v4 offset:2400
    s_waitcnt lgkmcnt(8)
    v_mfma_f32_32x32x16_bf16 v[84:99], v[100:103], v[104:107], v[84:99]
    v_mfma_f32_32x32x16_bf16 v[68:83], v[100:103], v[108:111], v[68:83]
    ds_read_b64 v[100:101], v3 offset:64
    ds_read_b64 v[102:103], v3 offset:72
    ds_read_b128 v[104:107], v4 offset:4992
    ds_read_b128 v[108:111], v4 offset:2432
    s_waitcnt lgkmcnt(8)
    v_mfma_f32_32x32x16_bf16 v[84:99], v[112:115], v[116:119], v[84:99]
    v_mfma_f32_32x32x16_bf16 v[68:83], v[112:115], v[120:123], v[68:83]
    ds_read_b64 v[112:113], v3 offset:160
    ds_read_b64 v[114:115], v3 offset:168
    ds_read_b128 v[116:119], v4 offset:4880
    ds_read_b128 v[120:123], v4 offset:2320
    s_waitcnt lgkmcnt(8)
    v_mfma_f32_32x32x16_bf16 v[84:99], v[124:127], v[128:131], v[84:99]
    v_mfma_f32_32x32x16_bf16 v[68:83], v[124:127], v[132:135], v[68:83]
    ds_read_b64 v[124:125], v3 offset:128
    ds_read_b64 v[126:127], v3 offset:136
    ds_read_b128 v[128:131], v4 offset:4912
    ds_read_b128 v[132:135], v4 offset:2352
    s_waitcnt lgkmcnt(8)
    v_mfma_f32_32x32x16_bf16 v[84:99], v[100:103], v[104:107], v[84:99]
    v_mfma_f32_32x32x16_bf16 v[68:83], v[100:103], v[108:111], v[68:83]
    ds_read_b64 v[100:101], v3 offset:224
    ds_read_b64 v[102:103], v3 offset:232
    ds_read_b128 v[104:107], v4 offset:4800
    ds_read_b128 v[108:111], v4 offset:2240
    s_waitcnt lgkmcnt(8)
    v_mfma_f32_32x32x16_bf16 v[84:99], v[112:115], v[116:119], v[84:99]
    v_mfma_f32_32x32x16_bf16 v[68:83], v[112:115], v[120:123], v[68:83]
    ds_read_b64 v[112:113], v3 offset:192
    ds_read_b64 v[114:115], v3 offset:200
    ds_read_b128 v[116:119], v4 offset:4832
    ds_read_b128 v[120:123], v4 offset:2272
    s_waitcnt lgkmcnt(8)
    v_mfma_f32_32x32x16_bf16 v[84:99], v[124:127], v[128:131], v[84:99]
    v_mfma_f32_32x32x16_bf16 v[68:83], v[124:127], v[132:135], v[68:83]
    ds_read_b64 v[124:125], v3 offset:288
    ds_read_b64 v[126:127], v3 offset:296
    ds_read_b128 v[128:131], v4 offset:4720
    ds_read_b128 v[132:135], v4 offset:2160
    s_waitcnt lgkmcnt(8)
    v_mfma_f32_32x32x16_bf16 v[84:99], v[100:103], v[104:107], v[84:99]
    v_mfma_f32_32x32x16_bf16 v[68:83], v[100:103], v[108:111], v[68:83]
    ds_read_b64 v[100:101], v3 offset:256
    ds_read_b64 v[102:103], v3 offset:264
    ds_read_b128 v[104:107], v4 offset:4752
    ds_read_b128 v[108:111], v4 offset:2192
    s_waitcnt lgkmcnt(8)
    v_mfma_f32_32x32x16_bf16 v[84:99], v[112:115], v[116:119], v[84:99]
    v_mfma_f32_32x32x16_bf16 v[68:83], v[112:115], v[120:123], v[68:83]
    ds_read_b64 v[112:113], v3 offset:352
    ds_read_b64 v[114:115], v3 offset:360
    ds_read_b128 v[116:119], v4 offset:4640
    ds_read_b128 v[120:123], v4 offset:2080
    s_waitcnt lgkmcnt(8)
    v_mfma_f32_32x32x16_bf16 v[84:99], v[124:127], v[128:131], v[84:99]
    v_mfma_f32_32x32x16_bf16 v[68:83], v[124:127], v[132:135], v[68:83]
    ds_read_b64 v[124:125], v3 offset:320
    ds_read_b64 v[126:127], v3 offset:328
    ds_read_b128 v[128:131], v4 offset:4672
    ds_read_b128 v[132:135], v4 offset:2112
    s_waitcnt lgkmcnt(8)
    v_mfma_f32_32x32x16_bf16 v[84:99], v[100:103], v[104:107], v[84:99]
    v_mfma_f32_32x32x16_bf16 v[68:83], v[100:103], v[108:111], v[68:83]
    ds_read_b64 v[100:101], v3 offset:416
    ds_read_b64 v[102:103], v3 offset:424
    ds_read_b128 v[104:107], v4 offset:4560
    ds_read_b128 v[108:111], v4 offset:2000
    s_waitcnt lgkmcnt(8)
    v_mfma_f32_32x32x16_bf16 v[84:99], v[112:115], v[116:119], v[84:99]
    v_mfma_f32_32x32x16_bf16 v[68:83], v[112:115], v[120:123], v[68:83]
    ds_read_b64 v[112:113], v3 offset:384
    ds_read_b64 v[114:115], v3 offset:392
    ds_read_b128 v[116:119], v4 offset:4592
    ds_read_b128 v[120:123], v4 offset:2032
    s_waitcnt lgkmcnt(8)
    v_mfma_f32_32x32x16_bf16 v[84:99], v[124:127], v[128:131], v[84:99]
    v_mfma_f32_32x32x16_bf16 v[68:83], v[124:127], v[132:135], v[68:83]
    ds_read_b64 v[124:125], v3 offset:480
    ds_read_b64 v[126:127], v3 offset:488
    ds_read_b128 v[128:131], v4 offset:4480
    ds_read_b128 v[132:135], v4 offset:1920
    s_waitcnt lgkmcnt(8)
    v_mfma_f32_32x32x16_bf16 v[84:99], v[100:103], v[104:107], v[84:99]
    v_mfma_f32_32x32x16_bf16 v[68:83], v[100:103], v[108:111], v[68:83]
    ds_read_b64 v[100:101], v3 offset:448
    ds_read_b64 v[102:103], v3 offset:456
    ds_read_b128 v[104:107], v4 offset:4512
    ds_read_b128 v[108:111], v4 offset:1952
    s_waitcnt lgkmcnt(8)
    v_mfma_f32_32x32x16_bf16 v[84:99], v[112:115], v[116:119], v[84:99]
    v_mfma_f32_32x32x16_bf16 v[68:83], v[112:115], v[120:123], v[68:83]
    ds_read_b64 v[112:113], v3 offset:544
    ds_read_b64 v[114:115], v3 offset:552
    ds_read_b128 v[116:119], v4 offset:4400
    ds_read_b128 v[120:123], v4 offset:1840
    s_waitcnt lgkmcnt(8)
    v_mfma_f32_32x32x16_bf16 v[84:99], v[124:127], v[128:131], v[84:99]
    v_mfma_f32_32x32x16_bf16 v[68:83], v[124:127], v[132:135], v[68:83]
    ds_read_b64 v[124:125], v3 offset:512
    ds_read_b64 v[126:127], v3 offset:520
    ds_read_b128 v[128:131], v4 offset:4432
    ds_read_b128 v[132:135], v4 offset:1872
    s_waitcnt lgkmcnt(8)
    v_mfma_f32_32x32x16_bf16 v[84:99], v[100:103], v[104:107], v[84:99]
    v_mfma_f32_32x32x16_bf16 v[68:83], v[100:103], v[108:111], v[68:83]
    ds_read_b64 v[100:101], v3 offset:608
    ds_read_b64 v[102:103], v3 offset:616
    ds_read_b128 v[104:107], v4 offset:4320
    ds_read_b128 v[108:111], v4 offset:1760
    s_waitcnt lgkmcnt(8)
    v_mfma_f32_32x32x16_bf16 v[84:99], v[112:115], v[116:119], v[84:99]
    v_mfma_f32_32x32x16_bf16 v[68:83], v[112:115], v[120:123], v[68:83]
    ds_read_b64 v[112:113], v3 offset:576
    ds_read_b64 v[114:115], v3 offset:584
    ds_read_b128 v[116:119], v4 offset:4352
    ds_read_b128 v[120:123], v4 offset:1792
    s_waitcnt lgkmcnt(8)
    v_mfma_f32_32x32x16_bf16 v[84:99], v[124:127], v[128:131], v[84:99]
    v_mfma_f32_32x32x16_bf16 v[68:83], v[124:127], v[132:135], v[68:83]
    ds_read_b64 v[124:125], v3 offset:672
    ds_read_b64 v[126:127], v3 offset:680
    ds_read_b128 v[128:131], v4 offset:4240
    ds_read_b128 v[132:135], v4 offset:1680
    s_waitcnt lgkmcnt(8)
    v_mfma_f32_32x32x16_bf16 v[84:99], v[100:103], v[104:107], v[84:99]
    v_mfma_f32_32x32x16_bf16 v[68:83], v[100:103], v[108:111], v[68:83]
    ds_read_b64 v[100:101], v3 offset:640
    ds_read_b64 v[102:103], v3 offset:648
    ds_read_b128 v[104:107], v4 offset:4272
    ds_read_b128 v[108:111], v4 offset:1712
    s_waitcnt lgkmcnt(8)
    v_mfma_f32_32x32x16_bf16 v[84:99], v[112:115], v[116:119], v[84:99]
    v_mfma_f32_32x32x16_bf16 v[68:83], v[112:115], v[120:123], v[68:83]
    ds_read_b64 v[112:113], v3 offset:736
    ds_read_b64 v[114:115], v3 offset:744
    ds_read_b128 v[116:119], v4 offset:4160
    ds_read_b128 v[120:123], v4 offset:1600
    s_waitcnt lgkmcnt(8)
    v_mfma_f32_32x32x16_bf16 v[84:99], v[124:127], v[128:131], v[84:99]
    v_mfma_f32_32x32x16_bf16 v[68:83], v[124:127], v[132:135], v[68:83]
    ds_read_b64 v[124:125], v3 offset:704
    ds_read_b64 v[126:127], v3 offset:712
    ds_read_b128 v[128:131], v4 offset:4192
    ds_read_b128 v[132:135], v4 offset:1632
    s_waitcnt lgkmcnt(8)
    v_mfma_f32_32x32x16_bf16 v[84:99], v[100:103], v[104:107], v[84:99]
    v_mfma_f32_32x32x16_bf16 v[68:83], v[100:103], v[108:111], v[68:83]
    ds_read_b64 v[100:101], v3 offset:800
    ds_read_b64 v[102:103], v3 offset:808
    ds_read_b128 v[104:107], v4 offset:4080
    ds_read_b128 v[108:111], v4 offset:1520
    s_waitcnt lgkmcnt(8)
    v_mfma_f32_32x32x16_bf16 v[84:99], v[112:115], v[116:119], v[84:99]
    v_mfma_f32_32x32x16_bf16 v[68:83], v[112:115], v[120:123], v[68:83]
    ds_read_b64 v[112:113], v3 offset:768
    ds_read_b64 v[114:115], v3 offset:776
    ds_read_b128 v[116:119], v4 offset:4112
    ds_read_b128 v[120:123], v4 offset:1552
    s_waitcnt lgkmcnt(8)
    v_mfma_f32_32x32x16_bf16 v[84:99], v[124:127], v[128:131], v[84:99]
    v_mfma_f32_32x32x16_bf16 v[68:83], v[124:127], v[132:135], v[68:83]
    ds_read_b64 v[124:125], v3 offset:864
    ds_read_b64 v[126:127], v3 offset:872
    ds_read_b128 v[128:131], v4 offset:4000
    ds_read_b128 v[132:135], v4 offset:1440
    s_waitcnt lgkmcnt(8)
    v_mfma_f32_32x32x16_bf16 v[84:99], v[100:103], v[104:107], v[84:99]
    v_mfma_f32_32x32x16_bf16 v[68:83], v[100:103], v[108:111], v[68:83]
    ds_read_b64 v[100:101], v3 offset:832
    ds_read_b64 v[102:103], v3 offset:840
    ds_read_b128 v[104:107], v4 offset:4032
    ds_read_b128 v[108:111], v4 offset:1472
    s_waitcnt lgkmcnt(8)
    v_mfma_f32_32x32x16_bf16 v[84:99], v[112:115], v[116:119], v[84:99]
    v_mfma_f32_32x32x16_bf16 v[68:83], v[112:115], v[120:123], v[68:83]
    ds_read_b64 v[112:113], v3 offset:928
    ds_read_b64 v[114:115], v3 offset:936
    ds_read_b128 v[116:119], v4 offset:3920
    ds_read_b128 v[120:123], v4 offset:1360
    s_waitcnt lgkmcnt(8)
    v_mfma_f32_32x32x16_bf16 v[84:99], v[124:127], v[128:131], v[84:99]
    v_mfma_f32_32x32x16_bf16 v[68:83], v[124:127], v[132:135], v[68:83]
    ds_read_b64 v[124:125], v3 offset:896
    ds_read_b64 v[126:127], v3 offset:904
    ds_read_b128 v[128:131], v4 offset:3952
    ds_read_b128 v[132:135], v4 offset:1392
    s_waitcnt lgkmcnt(8)
    v_mfma_f32_32x32x16_bf16 v[84:99], v[100:103], v[104:107], v[84:99]
    v_mfma_f32_32x32x16_bf16 v[68:83], v[100:103], v[108:111], v[68:83]
    ds_read_b64 v[100:101], v3 offset:992
    ds_read_b64 v[102:103], v3 offset:1000
    ds_read_b128 v[104:107], v4 offset:3840
    ds_read_b128 v[108:111], v4 offset:1280
    s_waitcnt lgkmcnt(8)
    v_mfma_f32_32x32x16_bf16 v[84:99], v[112:115], v[116:119], v[84:99]
    v_mfma_f32_32x32x16_bf16 v[68:83], v[112:115], v[120:123], v[68:83]
    ds_read_b64 v[112:113], v3 offset:960
    ds_read_b64 v[114:115], v3 offset:968
    ds_read_b128 v[116:119], v4 offset:3872
    ds_read_b128 v[120:123], v4 offset:1312
    s_waitcnt lgkmcnt(8)
    v_mfma_f32_32x32x16_bf16 v[84:99], v[124:127], v[128:131], v[84:99]
    v_mfma_f32_32x32x16_bf16 v[68:83], v[124:127], v[132:135], v[68:83]
    ds_read_b64 v[124:125], v3 offset:1056
    ds_read_b64 v[126:127], v3 offset:1064
    ds_read_b128 v[128:131], v4 offset:3760
    ds_read_b128 v[132:135], v4 offset:1200
    s_waitcnt lgkmcnt(8)
    v_mfma_f32_32x32x16_bf16 v[84:99], v[100:103], v[104:107], v[84:99]
    v_mfma_f32_32x32x16_bf16 v[68:83], v[100:103], v[108:111], v[68:83]
    ds_read_b64 v[100:101], v3 offset:1024
    ds_read_b64 v[102:103], v3 offset:1032
    ds_read_b128 v[104:107], v4 offset:3792
    ds_read_b128 v[108:111], v4 offset:1232
    s_waitcnt lgkmcnt(8)
    v_mfma_f32_32x32x16_bf16 v[84:99], v[112:115], v[116:119], v[84:99]
    v_mfma_f32_32x32x16_bf16 v[68:83], v[112:115], v[120:123], v[68:83]
    ds_read_b64 v[112:113], v3 offset:1120
    ds_read_b64 v[114:115], v3 offset:1128
    ds_read_b128 v[116:119], v4 offset:3680
    ds_read_b128 v[120:123], v4 offset:1120
    s_waitcnt lgkmcnt(8)
    v_mfma_f32_32x32x16_bf16 v[84:99], v[124:127], v[128:131], v[84:99]
    v_mfma_f32_32x32x16_bf16 v[68:83], v[124:127], v[132:135], v[68:83]
    ds_read_b64 v[124:125], v3 offset:1088
    ds_read_b64 v[126:127], v3 offset:1096
    ds_read_b128 v[128:131], v4 offset:3712
    ds_read_b128 v[132:135], v4 offset:1152
    s_waitcnt lgkmcnt(8)
    v_mfma_f32_32x32x16_bf16 v[84:99], v[100:103], v[104:107], v[84:99]
    v_mfma_f32_32x32x16_bf16 v[68:83], v[100:103], v[108:111], v[68:83]
    ds_read_b64 v[100:101], v3 offset:1184
    ds_read_b64 v[102:103], v3 offset:1192
    ds_read_b128 v[104:107], v4 offset:3600
    ds_read_b128 v[108:111], v4 offset:1040
    s_waitcnt lgkmcnt(8)
    v_mfma_f32_32x32x16_bf16 v[84:99], v[112:115], v[116:119], v[84:99]
    v_mfma_f32_32x32x16_bf16 v[68:83], v[112:115], v[120:123], v[68:83]
    ds_read_b64 v[112:113], v3 offset:1152
    ds_read_b64 v[114:115], v3 offset:1160
    ds_read_b128 v[116:119], v4 offset:3632
    ds_read_b128 v[120:123], v4 offset:1072
    s_waitcnt lgkmcnt(8)
    v_mfma_f32_32x32x16_bf16 v[84:99], v[124:127], v[128:131], v[84:99]
    v_mfma_f32_32x32x16_bf16 v[68:83], v[124:127], v[132:135], v[68:83]
    ds_read_b64 v[124:125], v3 offset:1248
    ds_read_b64 v[126:127], v3 offset:1256
    ds_read_b128 v[128:131], v4 offset:3520
    ds_read_b128 v[132:135], v4 offset:960
    s_waitcnt lgkmcnt(8)
    v_mfma_f32_32x32x16_bf16 v[84:99], v[100:103], v[104:107], v[84:99]
    v_mfma_f32_32x32x16_bf16 v[68:83], v[100:103], v[108:111], v[68:83]
    ds_read_b64 v[100:101], v3 offset:1216
    ds_read_b64 v[102:103], v3 offset:1224
    ds_read_b128 v[104:107], v4 offset:3552
    ds_read_b128 v[108:111], v4 offset:992
    s_waitcnt lgkmcnt(8)
    v_mfma_f32_32x32x16_bf16 v[84:99], v[112:115], v[116:119], v[84:99]
    v_mfma_f32_32x32x16_bf16 v[68:83], v[112:115], v[120:123], v[68:83]
    ds_read_b64 v[112:113], v3 offset:1312
    ds_read_b64 v[114:115], v3 offset:1320
    ds_read_b128 v[116:119], v4 offset:3440
    ds_read_b128 v[120:123], v4 offset:880
    s_waitcnt lgkmcnt(8)
    v_mfma_f32_32x32x16_bf16 v[84:99], v[124:127], v[128:131], v[84:99]
    v_mfma_f32_32x32x16_bf16 v[68:83], v[124:127], v[132:135], v[68:83]
    ds_read_b64 v[124:125], v3 offset:1280
    ds_read_b64 v[126:127], v3 offset:1288
    ds_read_b128 v[128:131], v4 offset:3472
    ds_read_b128 v[132:135], v4 offset:912
    s_waitcnt lgkmcnt(8)
    v_mfma_f32_32x32x16_bf16 v[84:99], v[100:103], v[104:107], v[84:99]
    v_mfma_f32_32x32x16_bf16 v[68:83], v[100:103], v[108:111], v[68:83]
    ds_read_b64 v[100:101], v3 offset:1376
    ds_read_b64 v[102:103], v3 offset:1384
    ds_read_b128 v[104:107], v4 offset:3360
    ds_read_b128 v[108:111], v4 offset:800
    s_waitcnt lgkmcnt(8)
    v_mfma_f32_32x32x16_bf16 v[84:99], v[112:115], v[116:119], v[84:99]
    v_mfma_f32_32x32x16_bf16 v[68:83], v[112:115], v[120:123], v[68:83]
    ds_read_b64 v[112:113], v3 offset:1344
    ds_read_b64 v[114:115], v3 offset:1352
    ds_read_b128 v[116:119], v4 offset:3392
    ds_read_b128 v[120:123], v4 offset:832
    s_waitcnt lgkmcnt(8)
    v_mfma_f32_32x32x16_bf16 v[84:99], v[124:127], v[128:131], v[84:99]
    v_mfma_f32_32x32x16_bf16 v[68:83], v[124:127], v[132:135], v[68:83]
    ds_read_b64 v[124:125], v3 offset:1440
    ds_read_b64 v[126:127], v3 offset:1448
    ds_read_b128 v[128:131], v4 offset:3280
    ds_read_b128 v[132:135], v4 offset:720
    s_waitcnt lgkmcnt(8)
    v_mfma_f32_32x32x16_bf16 v[84:99], v[100:103], v[104:107], v[84:99]
    v_mfma_f32_32x32x16_bf16 v[68:83], v[100:103], v[108:111], v[68:83]
    ds_read_b64 v[100:101], v3 offset:1408
    ds_read_b64 v[102:103], v3 offset:1416
    ds_read_b128 v[104:107], v4 offset:3312
    ds_read_b128 v[108:111], v4 offset:752
    s_waitcnt lgkmcnt(8)
    v_mfma_f32_32x32x16_bf16 v[84:99], v[112:115], v[116:119], v[84:99]
    v_mfma_f32_32x32x16_bf16 v[68:83], v[112:115], v[120:123], v[68:83]
    ds_read_b64 v[112:113], v3 offset:1504
    ds_read_b64 v[114:115], v3 offset:1512
    ds_read_b128 v[116:119], v4 offset:3200
    ds_read_b128 v[120:123], v4 offset:640
    s_waitcnt lgkmcnt(8)
    v_mfma_f32_32x32x16_bf16 v[84:99], v[124:127], v[128:131], v[84:99]
    v_mfma_f32_32x32x16_bf16 v[68:83], v[124:127], v[132:135], v[68:83]
    ds_read_b64 v[124:125], v3 offset:1472
    ds_read_b64 v[126:127], v3 offset:1480
    ds_read_b128 v[128:131], v4 offset:3232
    ds_read_b128 v[132:135], v4 offset:672
    s_waitcnt lgkmcnt(8)
    v_mfma_f32_32x32x16_bf16 v[84:99], v[100:103], v[104:107], v[84:99]
    v_mfma_f32_32x32x16_bf16 v[68:83], v[100:103], v[108:111], v[68:83]
    ds_read_b64 v[100:101], v3 offset:1568
    ds_read_b64 v[102:103], v3 offset:1576
    ds_read_b128 v[104:107], v4 offset:3120
    ds_read_b128 v[108:111], v4 offset:560
    s_waitcnt lgkmcnt(8)
    v_mfma_f32_32x32x16_bf16 v[84:99], v[112:115], v[116:119], v[84:99]
    v_mfma_f32_32x32x16_bf16 v[68:83], v[112:115], v[120:123], v[68:83]
    ds_read_b64 v[112:113], v3 offset:1536
    ds_read_b64 v[114:115], v3 offset:1544
    ds_read_b128 v[116:119], v4 offset:3152
    ds_read_b128 v[120:123], v4 offset:592
    s_waitcnt lgkmcnt(8)
    v_mfma_f32_32x32x16_bf16 v[84:99], v[124:127], v[128:131], v[84:99]
    v_mfma_f32_32x32x16_bf16 v[68:83], v[124:127], v[132:135], v[68:83]
    ds_read_b64 v[124:125], v3 offset:1632
    ds_read_b64 v[126:127], v3 offset:1640
    ds_read_b128 v[128:131], v4 offset:3040
    ds_read_b128 v[132:135], v4 offset:480
    s_waitcnt lgkmcnt(8)
    v_mfma_f32_32x32x16_bf16 v[84:99], v[100:103], v[104:107], v[84:99]
    v_mfma_f32_32x32x16_bf16 v[68:83], v[100:103], v[108:111], v[68:83]
    ds_read_b64 v[100:101], v3 offset:1600
    ds_read_b64 v[102:103], v3 offset:1608
    ds_read_b128 v[104:107], v4 offset:3072
    ds_read_b128 v[108:111], v4 offset:512
    s_waitcnt lgkmcnt(8)
    v_mfma_f32_32x32x16_bf16 v[84:99], v[112:115], v[116:119], v[84:99]
    v_mfma_f32_32x32x16_bf16 v[68:83], v[112:115], v[120:123], v[68:83]
    ds_read_b64 v[112:113], v3 offset:1696
    ds_read_b64 v[114:115], v3 offset:1704
    ds_read_b128 v[116:119], v4 offset:2960
    ds_read_b128 v[120:123], v4 offset:400
    s_waitcnt lgkmcnt(8)
    v_mfma_f32_32x32x16_bf16 v[84:99], v[124:127], v[128:131], v[84:99]
    v_mfma_f32_32x32x16_bf16 v[68:83], v[124:127], v[132:135], v[68:83]
    ds_read_b64 v[124:125], v3 offset:1664
    ds_read_b64 v[126:127], v3 offset:1672
    ds_read_b128 v[128:131], v4 offset:2992
    ds_read_b128 v[132:135], v4 offset:432
    s_waitcnt lgkmcnt(8)
    v_mfma_f32_32x32x16_bf16 v[84:99], v[100:103], v[104:107], v[84:99]
    v_mfma_f32_32x32x16_bf16 v[68:83], v[100:103], v[108:111], v[68:83]
    ds_read_b64 v[100:101], v3 offset:1760
    ds_read_b64 v[102:103], v3 offset:1768
    ds_read_b128 v[104:107], v4 offset:2880
    ds_read_b128 v[108:111], v4 offset:320
    s_waitcnt lgkmcnt(8)
    v_mfma_f32_32x32x16_bf16 v[84:99], v[112:115], v[116:119], v[84:99]
    v_mfma_f32_32x32x16_bf16 v[68:83], v[112:115], v[120:123], v[68:83]
    ds_read_b64 v[112:113], v3 offset:1728
    ds_read_b64 v[114:115], v3 offset:1736
    ds_read_b128 v[116:119], v4 offset:2912
    ds_read_b128 v[120:123], v4 offset:352
    s_waitcnt lgkmcnt(8)
    v_mfma_f32_32x32x16_bf16 v[84:99], v[124:127], v[128:131], v[84:99]
    v_mfma_f32_32x32x16_bf16 v[68:83], v[124:127], v[132:135], v[68:83]
    ds_read_b64 v[124:125], v3 offset:1824
    ds_read_b64 v[126:127], v3 offset:1832
    ds_read_b128 v[128:131], v4 offset:2800
    ds_read_b128 v[132:135], v4 offset:240
    s_waitcnt lgkmcnt(8)
    v_mfma_f32_32x32x16_bf16 v[84:99], v[100:103], v[104:107], v[84:99]
    v_mfma_f32_32x32x16_bf16 v[68:83], v[100:103], v[108:111], v[68:83]
    ds_read_b64 v[100:101], v3 offset:1792
    ds_read_b64 v[102:103], v3 offset:1800
    ds_read_b128 v[104:107], v4 offset:2832
    ds_read_b128 v[108:111], v4 offset:272
    s_waitcnt lgkmcnt(8)
    v_mfma_f32_32x32x16_bf16 v[84:99], v[112:115], v[116:119], v[84:99]
    v_mfma_f32_32x32x16_bf16 v[68:83], v[112:115], v[120:123], v[68:83]
    ds_read_b64 v[112:113], v3 offset:1888
    ds_read_b64 v[114:115], v3 offset:1896
    ds_read_b128 v[116:119], v4 offset:2720
    ds_read_b128 v[120:123], v4 offset:160
    s_waitcnt lgkmcnt(8)
    v_mfma_f32_32x32x16_bf16 v[84:99], v[124:127], v[128:131], v[84:99]
    v_mfma_f32_32x32x16_bf16 v[68:83], v[124:127], v[132:135], v[68:83]
    ds_read_b64 v[124:125], v3 offset:1856
    ds_read_b64 v[126:127], v3 offset:1864
    ds_read_b128 v[128:131], v4 offset:2752
    ds_read_b128 v[132:135], v4 offset:192
    s_waitcnt lgkmcnt(8)
    v_mfma_f32_32x32x16_bf16 v[84:99], v[100:103], v[104:107], v[84:99]
    v_mfma_f32_32x32x16_bf16 v[68:83], v[100:103], v[108:111], v[68:83]
    ds_read_b64 v[100:101], v3 offset:1952
    ds_read_b64 v[102:103], v3 offset:1960
    ds_read_b128 v[104:107], v4 offset:2640
    ds_read_b128 v[108:111], v4 offset:80
    s_waitcnt lgkmcnt(8)
    v_mfma_f32_32x32x16_bf16 v[84:99], v[112:115], v[116:119], v[84:99]
    v_mfma_f32_32x32x16_bf16 v[68:83], v[112:115], v[120:123], v[68:83]
    ds_read_b64 v[112:113], v3 offset:1920
    ds_read_b64 v[114:115], v3 offset:1928
    ds_read_b128 v[116:119], v4 offset:2672
    ds_read_b128 v[120:123], v4 offset:112
    s_waitcnt lgkmcnt(8)
    v_mfma_f32_32x32x16_bf16 v[84:99], v[124:127], v[128:131], v[84:99]
    v_mfma_f32_32x32x16_bf16 v[68:83], v[124:127], v[132:135], v[68:83]
    ds_read_b64 v[124:125], v3 offset:2016
    ds_read_b64 v[126:127], v3 offset:2024
    ds_read_b128 v[128:131], v4 offset:2560
    ds_read_b128 v[132:135], v4 offset:0
    s_waitcnt lgkmcnt(8)
    v_mfma_f32_32x32x16_bf16 v[84:99], v[100:103], v[104:107], v[84:99]
    v_mfma_f32_32x32x16_bf16 v[68:83], v[100:103], v[108:111], v[68:83]
    ds_read_b64 v[100:101], v3 offset:1984
    ds_read_b64 v[102:103], v3 offset:1992
    ds_read_b128 v[104:107], v4 offset:2592
    ds_read_b128 v[108:111], v4 offset:32
    s_waitcnt lgkmcnt(8)
    v_mfma_f32_32x32x16_bf16 v[84:99], v[112:115], v[116:119], v[84:99]
    v_mfma_f32_32x32x16_bf16 v[68:83], v[112:115], v[120:123], v[68:83]
    ds_read_b64 v[112:113], v3 offset:2080
    ds_read_b64 v[114:115], v3 offset:2088
    ds_read_b128 v[116:119], v4 offset:2480
    s_waitcnt lgkmcnt(7)
    v_mfma_f32_32x32x16_bf16 v[84:99], v[124:127], v[128:131], v[84:99]
    v_mfma_f32_32x32x16_bf16 v[68:83], v[124:127], v[132:135], v[68:83]
    ds_read_b64 v[124:125], v3 offset:2048
    ds_read_b64 v[126:127], v3 offset:2056
    ds_read_b128 v[128:131], v4 offset:2512
    s_waitcnt lgkmcnt(6)
    v_mfma_f32_32x32x16_bf16 v[84:99], v[100:103], v[104:107], v[84:99]
    v_mfma_f32_32x32x16_bf16 v[68:83], v[100:103], v[108:111], v[68:83]
    ds_read_b64 v[100:101], v3 offset:2144
    ds_read_b64 v[102:103], v3 offset:2152
    ds_read_b128 v[104:107], v4 offset:2400
    s_waitcnt lgkmcnt(6)
    v_mfma_f32_32x32x16_bf16 v[84:99], v[112:115], v[116:119], v[84:99]
    ds_read_b64 v[112:113], v3 offset:2112
    ds_read_b64 v[114:115], v3 offset:2120
    ds_read_b128 v[116:119], v4 offset:2432
    s_waitcnt lgkmcnt(6)
    v_mfma_f32_32x32x16_bf16 v[84:99], v[124:127], v[128:131], v[84:99]
    ds_read_b64 v[124:125], v3 offset:2208
    ds_read_b64 v[126:127], v3 offset:2216
    ds_read_b128 v[128:131], v4 offset:2320
    s_waitcnt lgkmcnt(6)
    v_mfma_f32_32x32x16_bf16 v[84:99], v[100:103], v[104:107], v[84:99]
    ds_read_b64 v[100:101], v3 offset:2176
    ds_read_b64 v[102:103], v3 offset:2184
    ds_read_b128 v[104:107], v4 offset:2352
    s_waitcnt lgkmcnt(6)
    v_mfma_f32_32x32x16_bf16 v[84:99], v[112:115], v[116:119], v[84:99]
    ds_read_b64 v[112:113], v3 offset:2272
    ds_read_b64 v[114:115], v3 offset:2280
    ds_read_b128 v[116:119], v4 offset:2240
    s_waitcnt lgkmcnt(6)
    v_mfma_f32_32x32x16_bf16 v[84:99], v[124:127], v[128:131], v[84:99]
    ds_read_b64 v[124:125], v3 offset:2240
    ds_read_b64 v[126:127], v3 offset:2248
    ds_read_b128 v[128:131], v4 offset:2272
    s_waitcnt lgkmcnt(6)
    v_mfma_f32_32x32x16_bf16 v[84:99], v[100:103], v[104:107], v[84:99]
    ds_read_b64 v[100:101], v3 offset:2336
    ds_read_b64 v[102:103], v3 offset:2344
    ds_read_b128 v[104:107], v4 offset:2160
    s_waitcnt lgkmcnt(6)
    v_mfma_f32_32x32x16_bf16 v[84:99], v[112:115], v[116:119], v[84:99]
    ds_read_b64 v[112:113], v3 offset:2304
    ds_read_b64 v[114:115], v3 offset:2312
    ds_read_b128 v[116:119], v4 offset:2192
    s_waitcnt lgkmcnt(6)
    v_mfma_f32_32x32x16_bf16 v[84:99], v[124:127], v[128:131], v[84:99]
    ds_read_b64 v[124:125], v3 offset:2400
    ds_read_b64 v[126:127], v3 offset:2408
    ds_read_b128 v[128:131], v4 offset:2080
    s_waitcnt lgkmcnt(6)
    v_mfma_f32_32x32x16_bf16 v[84:99], v[100:103], v[104:107], v[84:99]
    ds_read_b64 v[100:101], v3 offset:2368
    ds_read_b64 v[102:103], v3 offset:2376
    ds_read_b128 v[104:107], v4 offset:2112
    s_waitcnt lgkmcnt(6)
    v_mfma_f32_32x32x16_bf16 v[84:99], v[112:115], v[116:119], v[84:99]
    ds_read_b64 v[112:113], v3 offset:2464
    ds_read_b64 v[114:115], v3 offset:2472
    ds_read_b128 v[116:119], v4 offset:2000
    s_waitcnt lgkmcnt(6)
    v_mfma_f32_32x32x16_bf16 v[84:99], v[124:127], v[128:131], v[84:99]
    ds_read_b64 v[124:125], v3 offset:2432
    ds_read_b64 v[126:127], v3 offset:2440
    ds_read_b128 v[128:131], v4 offset:2032
    s_waitcnt lgkmcnt(6)
    v_mfma_f32_32x32x16_bf16 v[84:99], v[100:103], v[104:107], v[84:99]
    ds_read_b64 v[100:101], v3 offset:2528
    ds_read_b64 v[102:103], v3 offset:2536
    ds_read_b128 v[104:107], v4 offset:1920
    s_waitcnt lgkmcnt(6)
    v_mfma_f32_32x32x16_bf16 v[84:99], v[112:115], v[116:119], v[84:99]
    ds_read_b64 v[112:113], v3 offset:2496
    ds_read_b64 v[114:115], v3 offset:2504
    ds_read_b128 v[116:119], v4 offset:1952
    s_waitcnt lgkmcnt(6)
    v_mfma_f32_32x32x16_bf16 v[84:99], v[124:127], v[128:131], v[84:99]
    ds_read_b64 v[124:125], v3 offset:2592
    ds_read_b64 v[126:127], v3 offset:2600
    ds_read_b128 v[128:131], v4 offset:1840
    s_waitcnt lgkmcnt(6)
    v_mfma_f32_32x32x16_bf16 v[84:99], v[100:103], v[104:107], v[84:99]
    ds_read_b64 v[100:101], v3 offset:2560
    ds_read_b64 v[102:103], v3 offset:2568
    ds_read_b128 v[104:107], v4 offset:1872
    s_waitcnt lgkmcnt(6)
    v_mfma_f32_32x32x16_bf16 v[84:99], v[112:115], v[116:119], v[84:99]
    ds_read_b64 v[112:113], v3 offset:2656
    ds_read_b64 v[114:115], v3 offset:2664
    ds_read_b128 v[116:119], v4 offset:1760
    s_waitcnt lgkmcnt(6)
    v_mfma_f32_32x32x16_bf16 v[84:99], v[124:127], v[128:131], v[84:99]
    ds_read_b64 v[124:125], v3 offset:2624
    ds_read_b64 v[126:127], v3 offset:2632
    ds_read_b128 v[128:131], v4 offset:1792
    s_waitcnt lgkmcnt(6)
    v_mfma_f32_32x32x16_bf16 v[84:99], v[100:103], v[104:107], v[84:99]
    ds_read_b64 v[100:101], v3 offset:2720
    ds_read_b64 v[102:103], v3 offset:2728
    ds_read_b128 v[104:107], v4 offset:1680
    s_waitcnt lgkmcnt(6)
    v_mfma_f32_32x32x16_bf16 v[84:99], v[112:115], v[116:119], v[84:99]
    ds_read_b64 v[112:113], v3 offset:2688
    ds_read_b64 v[114:115], v3 offset:2696
    ds_read_b128 v[116:119], v4 offset:1712
    s_waitcnt lgkmcnt(6)
    v_mfma_f32_32x32x16_bf16 v[84:99], v[124:127], v[128:131], v[84:99]
    ds_read_b64 v[124:125], v3 offset:2784
    ds_read_b64 v[126:127], v3 offset:2792
    ds_read_b128 v[128:131], v4 offset:1600
    s_waitcnt lgkmcnt(6)
    v_mfma_f32_32x32x16_bf16 v[84:99], v[100:103], v[104:107], v[84:99]
    ds_read_b64 v[100:101], v3 offset:2752
    ds_read_b64 v[102:103], v3 offset:2760
    ds_read_b128 v[104:107], v4 offset:1632
    s_waitcnt lgkmcnt(6)
    v_mfma_f32_32x32x16_bf16 v[84:99], v[112:115], v[116:119], v[84:99]
    ds_read_b64 v[112:113], v3 offset:2848
    ds_read_b64 v[114:115], v3 offset:2856
    ds_read_b128 v[116:119], v4 offset:1520
    s_waitcnt lgkmcnt(6)
    v_mfma_f32_32x32x16_bf16 v[84:99], v[124:127], v[128:131], v[84:99]
    ds_read_b64 v[124:125], v3 offset:2816
    ds_read_b64 v[126:127], v3 offset:2824
    ds_read_b128 v[128:131], v4 offset:1552
    s_waitcnt lgkmcnt(6)
    v_mfma_f32_32x32x16_bf16 v[84:99], v[100:103], v[104:107], v[84:99]
    ds_read_b64 v[100:101], v3 offset:2912
    ds_read_b64 v[102:103], v3 offset:2920
    ds_read_b128 v[104:107], v4 offset:1440
    s_waitcnt lgkmcnt(6)
    v_mfma_f32_32x32x16_bf16 v[84:99], v[112:115], v[116:119], v[84:99]
    ds_read_b64 v[112:113], v3 offset:2880
    ds_read_b64 v[114:115], v3 offset:2888
    ds_read_b128 v[116:119], v4 offset:1472
    s_waitcnt lgkmcnt(6)
    v_mfma_f32_32x32x16_bf16 v[84:99], v[124:127], v[128:131], v[84:99]
    ds_read_b64 v[124:125], v3 offset:2976
    ds_read_b64 v[126:127], v3 offset:2984
    ds_read_b128 v[128:131], v4 offset:1360
    s_waitcnt lgkmcnt(6)
    v_mfma_f32_32x32x16_bf16 v[84:99], v[100:103], v[104:107], v[84:99]
    ds_read_b64 v[100:101], v3 offset:2944
    ds_read_b64 v[102:103], v3 offset:2952
    ds_read_b128 v[104:107], v4 offset:1392
    s_waitcnt lgkmcnt(6)
    v_mfma_f32_32x32x16_bf16 v[84:99], v[112:115], v[116:119], v[84:99]
    ds_read_b64 v[112:113], v3 offset:3040
    ds_read_b64 v[114:115], v3 offset:3048
    ds_read_b128 v[116:119], v4 offset:1280
    s_waitcnt lgkmcnt(6)
    v_mfma_f32_32x32x16_bf16 v[84:99], v[124:127], v[128:131], v[84:99]
    ds_read_b64 v[124:125], v3 offset:3008
    ds_read_b64 v[126:127], v3 offset:3016
    ds_read_b128 v[128:131], v4 offset:1312
    s_waitcnt lgkmcnt(6)
    v_mfma_f32_32x32x16_bf16 v[84:99], v[100:103], v[104:107], v[84:99]
    ds_read_b64 v[100:101], v3 offset:3104
    ds_read_b64 v[102:103], v3 offset:3112
    ds_read_b128 v[104:107], v4 offset:1200
    s_waitcnt lgkmcnt(6)
    v_mfma_f32_32x32x16_bf16 v[84:99], v[112:115], v[116:119], v[84:99]
    ds_read_b64 v[112:113], v3 offset:3072
    ds_read_b64 v[114:115], v3 offset:3080
    ds_read_b128 v[116:119], v4 offset:1232
    s_waitcnt lgkmcnt(6)
    v_mfma_f32_32x32x16_bf16 v[84:99], v[124:127], v[128:131], v[84:99]
    ds_read_b64 v[124:125], v3 offset:3168
    ds_read_b64 v[126:127], v3 offset:3176
    ds_read_b128 v[128:131], v4 offset:1120
    s_waitcnt lgkmcnt(6)
    v_mfma_f32_32x32x16_bf16 v[84:99], v[100:103], v[104:107], v[84:99]
    ds_read_b64 v[100:101], v3 offset:3136
    ds_read_b64 v[102:103], v3 offset:3144
    ds_read_b128 v[104:107], v4 offset:1152
    s_waitcnt lgkmcnt(6)
    v_mfma_f32_32x32x16_bf16 v[84:99], v[112:115], v[116:119], v[84:99]
    ds_read_b64 v[112:113], v3 offset:3232
    ds_read_b64 v[114:115], v3 offset:3240
    ds_read_b128 v[116:119], v4 offset:1040
    s_waitcnt lgkmcnt(6)
    v_mfma_f32_32x32x16_bf16 v[84:99], v[124:127], v[128:131], v[84:99]
    ds_read_b64 v[124:125], v3 offset:3200
    ds_read_b64 v[126:127], v3 offset:3208
    ds_read_b128 v[128:131], v4 offset:1072
    s_waitcnt lgkmcnt(6)
    v_mfma_f32_32x32x16_bf16 v[84:99], v[100:103], v[104:107], v[84:99]
    ds_read_b64 v[100:101], v3 offset:3296
    ds_read_b64 v[102:103], v3 offset:3304
    ds_read_b128 v[104:107], v4 offset:960
    s_waitcnt lgkmcnt(6)
    v_mfma_f32_32x32x16_bf16 v[84:99], v[112:115], v[116:119], v[84:99]
    ds_read_b64 v[112:113], v3 offset:3264
    ds_read_b64 v[114:115], v3 offset:3272
    ds_read_b128 v[116:119], v4 offset:992
    s_waitcnt lgkmcnt(6)
    v_mfma_f32_32x32x16_bf16 v[84:99], v[124:127], v[128:131], v[84:99]
    ds_read_b64 v[124:125], v3 offset:3360
    ds_read_b64 v[126:127], v3 offset:3368
    ds_read_b128 v[128:131], v4 offset:880
    s_waitcnt lgkmcnt(6)
    v_mfma_f32_32x32x16_bf16 v[84:99], v[100:103], v[104:107], v[84:99]
    ds_read_b64 v[100:101], v3 offset:3328
    ds_read_b64 v[102:103], v3 offset:3336
    ds_read_b128 v[104:107], v4 offset:912
    s_waitcnt lgkmcnt(6)
    v_mfma_f32_32x32x16_bf16 v[84:99], v[112:115], v[116:119], v[84:99]
    ds_read_b64 v[112:113], v3 offset:3424
    ds_read_b64 v[114:115], v3 offset:3432
    ds_read_b128 v[116:119], v4 offset:800
    s_waitcnt lgkmcnt(6)
    v_mfma_f32_32x32x16_bf16 v[84:99], v[124:127], v[128:131], v[84:99]
    ds_read_b64 v[124:125], v3 offset:3392
    ds_read_b64 v[126:127], v3 offset:3400
    ds_read_b128 v[128:131], v4 offset:832
    s_waitcnt lgkmcnt(6)
    v_mfma_f32_32x32x16_bf16 v[84:99], v[100:103], v[104:107], v[84:99]
    ds_read_b64 v[100:101], v3 offset:3488
    ds_read_b64 v[102:103], v3 offset:3496
    ds_read_b128 v[104:107], v4 offset:720
    s_waitcnt lgkmcnt(6)
    v_mfma_f32_32x32x16_bf16 v[84:99], v[112:115], v[116:119], v[84:99]
    ds_read_b64 v[112:113], v3 offset:3456
    ds_read_b64 v[114:115], v3 offset:3464
    ds_read_b128 v[116:119], v4 offset:752
    s_waitcnt lgkmcnt(6)
    v_mfma_f32_32x32x16_bf16 v[84:99], v[124:127], v[128:131], v[84:99]
    ds_read_b64 v[124:125], v3 offset:3552
    ds_read_b64 v[126:127], v3 offset:3560
    ds_read_b128 v[128:131], v4 offset:640
    s_waitcnt lgkmcnt(6)
    v_mfma_f32_32x32x16_bf16 v[84:99], v[100:103], v[104:107], v[84:99]
    ds_read_b64 v[100:101], v3 offset:3520
    ds_read_b64 v[102:103], v3 offset:3528
    ds_read_b128 v[104:107], v4 offset:672
    s_waitcnt lgkmcnt(6)
    v_mfma_f32_32x32x16_bf16 v[84:99], v[112:115], v[116:119], v[84:99]
    ds_read_b64 v[112:113], v3 offset:3616
    ds_read_b64 v[114:115], v3 offset:3624
    ds_read_b128 v[116:119], v4 offset:560
    s_waitcnt lgkmcnt(6)
    v_mfma_f32_32x32x16_bf16 v[84:99], v[124:127], v[128:131], v[84:99]
    ds_read_b64 v[124:125], v3 offset:3584
    ds_read_b64 v[126:127], v3 offset:3592
    ds_read_b128 v[128:131], v4 offset:592
    s_waitcnt lgkmcnt(6)
    v_mfma_f32_32x32x16_bf16 v[84:99], v[100:103], v[104:107], v[84:99]
    ds_read_b64 v[100:101], v3 offset:3680
    ds_read_b64 v[102:103], v3 offset:3688
    ds_read_b128 v[104:107], v4 offset:480
    s_waitcnt lgkmcnt(6)
    v_mfma_f32_32x32x16_bf16 v[84:99], v[112:115], v[116:119], v[84:99]
    ds_read_b64 v[112:113], v3 offset:3648
    ds_read_b64 v[114:115], v3 offset:3656
    ds_read_b128 v[116:119], v4 offset:512
    s_waitcnt lgkmcnt(6)
    v_mfma_f32_32x32x16_bf16 v[84:99], v[124:127], v[128:131], v[84:99]
    ds_read_b64 v[124:125], v3 offset:3744
    ds_read_b64 v[126:127], v3 offset:3752
    ds_read_b128 v[128:131], v4 offset:400
    s_waitcnt lgkmcnt(6)
    v_mfma_f32_32x32x16_bf16 v[84:99], v[100:103], v[104:107], v[84:99]
    ds_read_b64 v[100:101], v3 offset:3712
    ds_read_b64 v[102:103], v3 offset:3720
    ds_read_b128 v[104:107], v4 offset:432
    s_waitcnt lgkmcnt(6)
    v_mfma_f32_32x32x16_bf16 v[84:99], v[112:115], v[116:119], v[84:99]
    ds_read_b64 v[112:113], v3 offset:3808
    ds_read_b64 v[114:115], v3 offset:3816
    ds_read_b128 v[116:119], v4 offset:320
    s_waitcnt lgkmcnt(6)
    v_mfma_f32_32x32x16_bf16 v[84:99], v[124:127], v[128:131], v[84:99]
    ds_read_b64 v[124:125], v3 offset:3776
    ds_read_b64 v[126:127], v3 offset:3784
    ds_read_b128 v[128:131], v4 offset:352
    s_waitcnt lgkmcnt(6)
    v_mfma_f32_32x32x16_bf16 v[84:99], v[100:103], v[104:107], v[84:99]
    ds_read_b64 v[100:101], v3 offset:3872
    ds_read_b64 v[102:103], v3 offset:3880
    ds_read_b128 v[104:107], v4 offset:240
    s_waitcnt lgkmcnt(6)
    v_mfma_f32_32x32x16_bf16 v[84:99], v[112:115], v[116:119], v[84:99]
    ds_read_b64 v[112:113], v3 offset:3840
    ds_read_b64 v[114:115], v3 offset:3848
    ds_read_b128 v[116:119], v4 offset:272
    s_waitcnt lgkmcnt(6)
    v_mfma_f32_32x32x16_bf16 v[84:99], v[124:127], v[128:131], v[84:99]
    ds_read_b64 v[124:125], v3 offset:3936
    ds_read_b64 v[126:127], v3 offset:3944
    ds_read_b128 v[128:131], v4 offset:160
    s_waitcnt lgkmcnt(6)
    v_mfma_f32_32x32x16_bf16 v[84:99], v[100:103], v[104:107], v[84:99]
    ds_read_b64 v[100:101], v3 offset:3904
    ds_read_b64 v[102:103], v3 offset:3912
    ds_read_b128 v[104:107], v4 offset:192
    s_waitcnt lgkmcnt(6)
    v_mfma_f32_32x32x16_bf16 v[84:99], v[112:115], v[116:119], v[84:99]
    ds_read_b64 v[112:113], v3 offset:4000
    ds_read_b64 v[114:115], v3 offset:4008
    ds_read_b128 v[116:119], v4 offset:80
    s_waitcnt lgkmcnt(6)
    v_mfma_f32_32x32x16_bf16 v[84:99], v[124:127], v[128:131], v[84:99]
    ds_read_b64 v[124:125], v3 offset:3968
    ds_read_b64 v[126:127], v3 offset:3976
    ds_read_b128 v[128:131], v4 offset:112
    s_waitcnt lgkmcnt(6)
    v_mfma_f32_32x32x16_bf16 v[84:99], v[100:103], v[104:107], v[84:99]
    ds_read_b64 v[100:101], v3 offset:4064
    ds_read_b64 v[102:103], v3 offset:4072
    ds_read_b128 v[104:107], v4 offset:0
    s_waitcnt lgkmcnt(6)
    v_mfma_f32_32x32x16_bf16 v[84:99], v[112:115], v[116:119], v[84:99]
    ds_read_b64 v[112:113], v3 offset:4032
    ds_read_b64 v[114:115], v3 offset:4040
    ds_read_b128 v[116:119], v4 offset:32
    s_waitcnt lgkmcnt(6)
    v_mfma_f32_32x32x16_bf16 v[84:99], v[124:127], v[128:131], v[84:99]
    s_waitcnt lgkmcnt(3)
    v_mfma_f32_32x32x16_bf16 v[84:99], v[100:103], v[104:107], v[84:99]
    s_waitcnt lgkmcnt(0)
    v_mfma_f32_32x32x16_bf16 v[84:99], v[112:115], v[116:119], v[84:99]
    s_nop 15
    s_nop 3
    v_cvt_pk_bf16_f32 v10, v68, v69
    v_cvt_pk_bf16_f32 v11, v70, v71
    ds_write_b64 v5, v[10:11] offset:0
    v_cvt_pk_bf16_f32 v10, v72, v73
    v_cvt_pk_bf16_f32 v11, v74, v75
    ds_write_b64 v5, v[10:11] offset:16
    v_cvt_pk_bf16_f32 v10, v76, v77
    v_cvt_pk_bf16_f32 v11, v78, v79
    ds_write_b64 v5, v[10:11] offset:32
    v_cvt_pk_bf16_f32 v10, v80, v81
    v_cvt_pk_bf16_f32 v11, v82, v83
    ds_write_b64 v5, v[10:11] offset:48
    v_cvt_pk_bf16_f32 v10, v84, v85
    v_cvt_pk_bf16_f32 v11, v86, v87
    ds_write_b64 v5, v[10:11] offset:2304
    v_cvt_pk_bf16_f32 v10, v88, v89
    v_cvt_pk_bf16_f32 v11, v90, v91
    ds_write_b64 v5, v[10:11] offset:2320
    v_cvt_pk_bf16_f32 v10, v92, v93
    v_cvt_pk_bf16_f32 v11, v94, v95
    ds_write_b64 v5, v[10:11] offset:2336
    v_cvt_pk_bf16_f32 v10, v96, v97
    v_cvt_pk_bf16_f32 v11, v98, v99
    ds_write_b64 v5, v[10:11] offset:2352
    s_waitcnt lgkmcnt(0)
    s_barrier
    v_lshlrev_b32 v32, 1, v8
    s_lshl_b32 s7, s4, 1
    v_subrev_u32 v32, s7, v32
    s_lshl_b32 s7, s5, 10
    v_add_u32 v32, s7, v32
    ds_read_u16 v10, v6 offset:0
    ds_read_u16 v11, v6 offset:25264
    ds_read_u16 v12, v7 offset:0
    ds_read_u16 v13, v7 offset:25264
    s_waitcnt lgkmcnt(0)
    v_lshlrev_b32 v10, 16, v10
    v_lshlrev_b32 v11, 16, v11
    v_lshlrev_b32 v12, 16, v12
    v_lshlrev_b32 v13, 16, v13
    v_lshlrev_b32 v14, 16, v36
    v_and_b32 v15, 0xffff0000, v36
    v_lshlrev_b32 v16, 16, v37
    v_and_b32 v17, 0xffff0000, v37
    v_mul_f32 v14, s80, v14
    v_mul_f32 v15, s81, v15
    v_mul_f32 v16, s82, v16
    v_mul_f32 v17, s83, v17
    v_cvt_pk_bf16_f32 v30, v14, v15
    v_cvt_pk_bf16_f32 v31, v16, v17
    v_lshlrev_b32 v14, 16, v30
    v_and_b32 v15, 0xffff0000, v30
    v_lshlrev_b32 v16, 16, v31
    v_and_b32 v17, 0xffff0000, v31
    v_add_f32 v10, v10, v14
    v_add_f32 v11, v11, v15
    v_add_f32 v12, v12, v16
    v_add_f32 v13, v13, v17
    v_cvt_pk_bf16_f32 v18, v10, v11
    v_cvt_pk_bf16_f32 v19, v12, v13
    s_mov_b32 s7, 0
    buffer_store_dwordx2 v[18:19], v32, s[20:23], s7 offen
    ds_read_u16 v10, v6 offset:144
    ds_read_u16 v11, v6 offset:25408
    ds_read_u16 v12, v7 offset:144
    ds_read_u16 v13, v7 offset:25408
    s_waitcnt lgkmcnt(0)
    v_lshlrev_b32 v10, 16, v10
    v_lshlrev_b32 v11, 16, v11
    v_lshlrev_b32 v12, 16, v12
    v_lshlrev_b32 v13, 16, v13
    v_lshlrev_b32 v14, 16, v38
    v_and_b32 v15, 0xffff0000, v38
    v_lshlrev_b32 v16, 16, v39
    v_and_b32 v17, 0xffff0000, v39
    v_mul_f32 v14, s80, v14
    v_mul_f32 v15, s81, v15
    v_mul_f32 v16, s82, v16
    v_mul_f32 v17, s83, v17
    v_cvt_pk_bf16_f32 v30, v14, v15
    v_cvt_pk_bf16_f32 v31, v16, v17
    v_lshlrev_b32 v14, 16, v30
    v_and_b32 v15, 0xffff0000, v30
    v_lshlrev_b32 v16, 16, v31
    v_and_b32 v17, 0xffff0000, v31
    v_add_f32 v10, v10, v14
    v_add_f32 v11, v11, v15
    v_add_f32 v12, v12, v16
    v_add_f32 v13, v13, v17
    v_cvt_pk_bf16_f32 v18, v10, v11
    v_cvt_pk_bf16_f32 v19, v12, v13
    s_mov_b32 s7, 131072
    buffer_store_dwordx2 v[18:19], v32, s[20:23], s7 offen
    ds_read_u16 v10, v6 offset:288
    ds_read_u16 v11, v6 offset:25552
    ds_read_u16 v12, v7 offset:288
    ds_read_u16 v13, v7 offset:25552
    s_waitcnt lgkmcnt(0)
    v_lshlrev_b32 v10, 16, v10
    v_lshlrev_b32 v11, 16, v11
    v_lshlrev_b32 v12, 16, v12
    v_lshlrev_b32 v13, 16, v13
    v_lshlrev_b32 v14, 16, v40
    v_and_b32 v15, 0xffff0000, v40
    v_lshlrev_b32 v16, 16, v41
    v_and_b32 v17, 0xffff0000, v41
    v_mul_f32 v14, s80, v14
    v_mul_f32 v15, s81, v15
    v_mul_f32 v16, s82, v16
    v_mul_f32 v17, s83, v17
    v_cvt_pk_bf16_f32 v30, v14, v15
    v_cvt_pk_bf16_f32 v31, v16, v17
    v_lshlrev_b32 v14, 16, v30
    v_and_b32 v15, 0xffff0000, v30
    v_lshlrev_b32 v16, 16, v31
    v_and_b32 v17, 0xffff0000, v31
    v_add_f32 v10, v10, v14
    v_add_f32 v11, v11, v15
    v_add_f32 v12, v12, v16
    v_add_f32 v13, v13, v17
    v_cvt_pk_bf16_f32 v18, v10, v11
    v_cvt_pk_bf16_f32 v19, v12, v13
    s_mov_b32 s7, 262144
    buffer_store_dwordx2 v[18:19], v32, s[20:23], s7 offen
    ds_read_u16 v10, v6 offset:432
    ds_read_u16 v11, v6 offset:25696
    ds_read_u16 v12, v7 offset:432
    ds_read_u16 v13, v7 offset:25696
    s_waitcnt lgkmcnt(0)
    v_lshlrev_b32 v10, 16, v10
    v_lshlrev_b32 v11, 16, v11
    v_lshlrev_b32 v12, 16, v12
    v_lshlrev_b32 v13, 16, v13
    v_lshlrev_b32 v14, 16, v42
    v_and_b32 v15, 0xffff0000, v42
    v_lshlrev_b32 v16, 16, v43
    v_and_b32 v17, 0xffff0000, v43
    v_mul_f32 v14, s80, v14
    v_mul_f32 v15, s81, v15
    v_mul_f32 v16, s82, v16
    v_mul_f32 v17, s83, v17
    v_cvt_pk_bf16_f32 v30, v14, v15
    v_cvt_pk_bf16_f32 v31, v16, v17
    v_lshlrev_b32 v14, 16, v30
    v_and_b32 v15, 0xffff0000, v30
    v_lshlrev_b32 v16, 16, v31
    v_and_b32 v17, 0xffff0000, v31
    v_add_f32 v10, v10, v14
    v_add_f32 v11, v11, v15
    v_add_f32 v12, v12, v16
    v_add_f32 v13, v13, v17
    v_cvt_pk_bf16_f32 v18, v10, v11
    v_cvt_pk_bf16_f32 v19, v12, v13
    s_mov_b32 s7, 393216
    buffer_store_dwordx2 v[18:19], v32, s[20:23], s7 offen
    ds_read_u16 v10, v6 offset:576
    ds_read_u16 v11, v6 offset:25840
    ds_read_u16 v12, v7 offset:576
    ds_read_u16 v13, v7 offset:25840
    s_waitcnt lgkmcnt(0)
    v_lshlrev_b32 v10, 16, v10
    v_lshlrev_b32 v11, 16, v11
    v_lshlrev_b32 v12, 16, v12
    v_lshlrev_b32 v13, 16, v13
    v_lshlrev_b32 v14, 16, v44
    v_and_b32 v15, 0xffff0000, v44
    v_lshlrev_b32 v16, 16, v45
    v_and_b32 v17, 0xffff0000, v45
    v_mul_f32 v14, s80, v14
    v_mul_f32 v15, s81, v15
    v_mul_f32 v16, s82, v16
    v_mul_f32 v17, s83, v17
    v_cvt_pk_bf16_f32 v30, v14, v15
    v_cvt_pk_bf16_f32 v31, v16, v17
    v_lshlrev_b32 v14, 16, v30
    v_and_b32 v15, 0xffff0000, v30
    v_lshlrev_b32 v16, 16, v31
    v_and_b32 v17, 0xffff0000, v31
    v_add_f32 v10, v10, v14
    v_add_f32 v11, v11, v15
    v_add_f32 v12, v12, v16
    v_add_f32 v13, v13, v17
    v_cvt_pk_bf16_f32 v18, v10, v11
    v_cvt_pk_bf16_f32 v19, v12, v13
    s_mov_b32 s7, 524288
    buffer_store_dwordx2 v[18:19], v32, s[20:23], s7 offen
    ds_read_u16 v10, v6 offset:720
    ds_read_u16 v11, v6 offset:25984
    ds_read_u16 v12, v7 offset:720
    ds_read_u16 v13, v7 offset:25984
    s_waitcnt lgkmcnt(0)
    v_lshlrev_b32 v10, 16, v10
    v_lshlrev_b32 v11, 16, v11
    v_lshlrev_b32 v12, 16, v12
    v_lshlrev_b32 v13, 16, v13
    v_lshlrev_b32 v14, 16, v46
    v_and_b32 v15, 0xffff0000, v46
    v_lshlrev_b32 v16, 16, v47
    v_and_b32 v17, 0xffff0000, v47
    v_mul_f32 v14, s80, v14
    v_mul_f32 v15, s81, v15
    v_mul_f32 v16, s82, v16
    v_mul_f32 v17, s83, v17
    v_cvt_pk_bf16_f32 v30, v14, v15
    v_cvt_pk_bf16_f32 v31, v16, v17
    v_lshlrev_b32 v14, 16, v30
    v_and_b32 v15, 0xffff0000, v30
    v_lshlrev_b32 v16, 16, v31
    v_and_b32 v17, 0xffff0000, v31
    v_add_f32 v10, v10, v14
    v_add_f32 v11, v11, v15
    v_add_f32 v12, v12, v16
    v_add_f32 v13, v13, v17
    v_cvt_pk_bf16_f32 v18, v10, v11
    v_cvt_pk_bf16_f32 v19, v12, v13
    s_mov_b32 s7, 655360
    buffer_store_dwordx2 v[18:19], v32, s[20:23], s7 offen
    ds_read_u16 v10, v6 offset:864
    ds_read_u16 v11, v6 offset:26128
    ds_read_u16 v12, v7 offset:864
    ds_read_u16 v13, v7 offset:26128
    s_waitcnt lgkmcnt(0)
    v_lshlrev_b32 v10, 16, v10
    v_lshlrev_b32 v11, 16, v11
    v_lshlrev_b32 v12, 16, v12
    v_lshlrev_b32 v13, 16, v13
    v_lshlrev_b32 v14, 16, v48
    v_and_b32 v15, 0xffff0000, v48
    v_lshlrev_b32 v16, 16, v49
    v_and_b32 v17, 0xffff0000, v49
    v_mul_f32 v14, s80, v14
    v_mul_f32 v15, s81, v15
    v_mul_f32 v16, s82, v16
    v_mul_f32 v17, s83, v17
    v_cvt_pk_bf16_f32 v30, v14, v15
    v_cvt_pk_bf16_f32 v31, v16, v17
    v_lshlrev_b32 v14, 16, v30
    v_and_b32 v15, 0xffff0000, v30
    v_lshlrev_b32 v16, 16, v31
    v_and_b32 v17, 0xffff0000, v31
    v_add_f32 v10, v10, v14
    v_add_f32 v11, v11, v15
    v_add_f32 v12, v12, v16
    v_add_f32 v13, v13, v17
    v_cvt_pk_bf16_f32 v18, v10, v11
    v_cvt_pk_bf16_f32 v19, v12, v13
    s_mov_b32 s7, 786432
    buffer_store_dwordx2 v[18:19], v32, s[20:23], s7 offen
    ds_read_u16 v10, v6 offset:1008
    ds_read_u16 v11, v6 offset:26272
    ds_read_u16 v12, v7 offset:1008
    ds_read_u16 v13, v7 offset:26272
    s_waitcnt lgkmcnt(0)
    v_lshlrev_b32 v10, 16, v10
    v_lshlrev_b32 v11, 16, v11
    v_lshlrev_b32 v12, 16, v12
    v_lshlrev_b32 v13, 16, v13
    v_lshlrev_b32 v14, 16, v50
    v_and_b32 v15, 0xffff0000, v50
    v_lshlrev_b32 v16, 16, v51
    v_and_b32 v17, 0xffff0000, v51
    v_mul_f32 v14, s80, v14
    v_mul_f32 v15, s81, v15
    v_mul_f32 v16, s82, v16
    v_mul_f32 v17, s83, v17
    v_cvt_pk_bf16_f32 v30, v14, v15
    v_cvt_pk_bf16_f32 v31, v16, v17
    v_lshlrev_b32 v14, 16, v30
    v_and_b32 v15, 0xffff0000, v30
    v_lshlrev_b32 v16, 16, v31
    v_and_b32 v17, 0xffff0000, v31
    v_add_f32 v10, v10, v14
    v_add_f32 v11, v11, v15
    v_add_f32 v12, v12, v16
    v_add_f32 v13, v13, v17
    v_cvt_pk_bf16_f32 v18, v10, v11
    v_cvt_pk_bf16_f32 v19, v12, v13
    s_mov_b32 s7, 917504
    buffer_store_dwordx2 v[18:19], v32, s[20:23], s7 offen
    s_branch L_end
L_end:
s_endpgm
.section .rodata,"a"
.p2align 6
.amdhsa_kernel concat_heads__ssm_conv_s4d__ssm_conv_h3__prompt_kernel
  .amdhsa_next_free_vgpr 256
  .amdhsa_next_free_sgpr 102
  .amdhsa_accum_offset 256
  .amdhsa_group_segment_fixed_size 0
  .amdhsa_kernarg_size 128
  .amdhsa_user_sgpr_count 2
  .amdhsa_user_sgpr_kernarg_segment_ptr 1
  .amdhsa_system_sgpr_workgroup_id_x 1
.end_amdhsa_kernel
```
